```python
import torch

def _softmax(x, axis=-1):
    return torch.softmax(x, dim=axis)
def _gelu(x):
    return torch.nn.functional.gelu(x, approximate="tanh")
def _silu(x):
    return torch.nn.functional.silu(x)
def _sigmoid(x):
    return torch.sigmoid(x)
def _layernorm(x, axis=-1, eps=1e-5):
    m = x.mean(dim=axis, keepdim=True)
    v = x.var(dim=axis, keepdim=True, unbiased=False)
    return (x - m) / torch.sqrt(v + eps)
def _scatter_add(tgt, idx, src, axis=0):
    return tgt.clone().index_add_(axis, idx, src)
def _segment_sum(src, seg, n):
    out = torch.zeros((n,) + src.shape[1:], dtype=src.dtype)
    return out.index_add_(0, seg, src)
def _pad(x, pw):
    flat = tuple(v for pair in reversed(pw) for v in pair)
    return torch.nn.functional.pad(x, flat)

kernel_name = 'gated_mix__ssm_conv_s5__glu_gated_swiglu__prompt'

def setup_inputs():

    _w = (lambda a: (lambda t: t.to(torch.bfloat16) if t.is_floating_point() else t)(torch.as_tensor(a)))
    def _A_setup():
        B, S, D = 1, 2048, 512
        P = D
        Lambda_re = -0.5 * (lambda _x: torch.exp(torch.as_tensor(_x)))((lambda *s: torch.randn(*s, dtype=torch.bfloat16) * 0.2)(P))
        Lambda_im = (lambda *s: torch.randn(*s, dtype=torch.bfloat16) * 0.4)(P) * 1.0
        B_re = (lambda *s: torch.randn(*s, dtype=torch.bfloat16) * 0.2)(P, D) * (D ** -0.5)
        B_im = (lambda *s: torch.randn(*s, dtype=torch.bfloat16) * 0.2)(P, D) * (D ** -0.5)
        C_re = (lambda *s: torch.randn(*s, dtype=torch.bfloat16) * 0.2)(D, P) * (P ** -0.5)
        C_im = (lambda *s: torch.randn(*s, dtype=torch.bfloat16) * 0.2)(D, P) * (P ** -0.5)
        log_dt = (lambda *s: torch.randn(*s, dtype=torch.bfloat16) * 0.2)(P) * 0.3 - 2.0
        Dskip = (lambda *s: torch.randn(*s, dtype=torch.bfloat16) * 0.05)(D)
        return {
            "x": _w((lambda *s: torch.randn(*s, dtype=torch.bfloat16) * 0.05)(B, S, D)),
            "Lambda_re": _w(Lambda_re),
            "Lambda_im": _w(Lambda_im),
            "B_re": _w(B_re),
            "B_im": _w(B_im),
            "C_re": _w(C_re),
            "C_im": _w(C_im),
            "log_dt": _w(log_dt),
            "Dskip": _w(Dskip),
        }
    _A_in = _A_setup()

    def _B_setup():
        B, S, D, F = 1, 2048, 512, 1376
        return {
            "x": _w((lambda *s: torch.randn(*s, dtype=torch.bfloat16) * 0.05)(B, S, D)),
            "w1": _w((lambda *s: torch.randn(*s, dtype=torch.bfloat16) * 0.8)(D, F) * (2.0 / D) ** 0.5),
            "w3": _w((lambda *s: torch.randn(*s, dtype=torch.bfloat16) * 0.8)(D, F) * (2.0 / D) ** 0.5),
            "w2": _w((lambda *s: torch.randn(*s, dtype=torch.bfloat16) * 0.8)(F, D) * (2.0 / F) ** 0.5),
        }
    _B_in = _B_setup()

    return {
        "A_x": _A_in["x"],
        "A_Lambda_re": _A_in["Lambda_re"],
        "A_Lambda_im": _A_in["Lambda_im"],
        "A_B_re": _A_in["B_re"],
        "A_B_im": _A_in["B_im"],
        "A_C_re": _A_in["C_re"],
        "A_C_im": _A_in["C_im"],
        "A_log_dt": _A_in["log_dt"],
        "A_Dskip": _A_in["Dskip"],
        "B_x": _B_in["x"],
        "B_w1": _B_in["w1"],
        "B_w3": _B_in["w3"],
        "B_w2": _B_in["w2"],
        "gate_w": _w((lambda *s: torch.randn(*s, dtype=torch.bfloat16) * 0.05)(512) * 16.0),
    }

def reference(A_x, A_Lambda_re, A_Lambda_im, A_B_re, A_B_im, A_C_re, A_C_im, A_log_dt, A_Dskip, B_x, B_w1, B_w3, B_w2, gate_w):
    def _A_ref(x, Lambda_re, Lambda_im, B_re, B_im, C_re, C_im, log_dt, Dskip):
        Bsz, L, H = x.shape
        Lam = Lambda_re + 1j * Lambda_im
        Bmat = B_re + 1j * B_im
        Cmat = C_re + 1j * C_im
        dt = torch.exp(log_dt)
        Lam_bar = torch.exp(dt * Lam)
        B_bar = ((Lam_bar - 1.0) / Lam)[:, None] * Bmat
        Bu = torch.einsum("bld,pd->blp", x + 0j, B_bar)
        h = torch.zeros_like(Bu[:, 0, :])
        hs = []
        for t in range(L):
            h = Lam_bar[None, :] * h + Bu[:, t, :]
            hs.append(h)
        hseq = torch.stack(hs, 1)
        y = 2.0 * torch.einsum("blp,dp->bld", hseq, Cmat).real + x * Dskip[None, None, :]
        return y

    def _B_ref(x, w1, w3, w2):
        gate = torch.einsum("bsd,df->bsf", x, w1)
        up = torch.einsum("bsd,df->bsf", x, w3)
        h = _silu(gate) * up
        out = torch.einsum("bsf,fd->bsd", h, w2)
        return out

    x = A_x
    g = _sigmoid((x * gate_w).sum(-1, keepdims=True))
    a = _A_ref(x, A_Lambda_re, A_Lambda_im, A_B_re, A_B_im, A_C_re, A_C_im, A_log_dt, A_Dskip)
    b = _B_ref(x, B_w1, B_w3, B_w2)
    return g * a + (1 - g) * b
```

```asm
; @launch grid=(256,1,1) block=(512,1,1) lds=163840
.amdgcn_target "amdgcn-amd-amdhsa--gfx950"
.text
.globl gated_mix__ssm_conv_s5__glu_gated_swiglu__prompt_kernel
.p2align 8
.type gated_mix__ssm_conv_s5__glu_gated_swiglu__prompt_kernel,@function
gated_mix__ssm_conv_s5__glu_gated_swiglu__prompt_kernel:
  s_cmp_ge_u32 s2, 256
  s_cbranch_scc1 L_end
  s_load_dwordx16 s[16:31], s[0:1], 0
  s_load_dwordx8 s[32:39], s[0:1], 80
  s_load_dwordx2 s[42:43], s[0:1], 128
  s_load_dwordx2 s[40:41], s[0:1], 64
  s_load_dwordx2 s[84:85], s[0:1], 112
  v_lshrrev_b32 v2, 6, v0
  v_and_b32 v1, 63, v0
  v_readfirstlane_b32 s3, v2
  s_bfe_u32 s4, s2, 0x10002
  s_lshl_b32 s4, s4, 3
  s_bfe_u32 s6, s2, 0x30003
  s_add_u32 s4, s4, s6
  s_and_b32 s5, s2, 3
  s_lshl_b32 s5, s5, 2
  s_lshr_b32 s6, s2, 6
  s_add_u32 s5, s5, s6
  s_and_b32 s7, s3, 3
  v_and_b32 v8, 31, v1
  v_lshrrev_b32 v9, 5, v1
  s_lshl_b32 s8, s7, 12
  s_add_u32 s15, s4, s5
  s_and_b32 s15, s15, 1
  s_add_u32 s83, s4, s5
  s_add_u32 s83, s83, s5
  s_cmp_lt_u32 s3, 4
  s_cbranch_scc1 L_S
  v_lshrrev_b32 v10, 4, v1
  v_and_b32 v11, 7, v1
  v_xor_b32 v10, v10, v11
  v_lshlrev_b32 v10, 4, v10
  v_bfe_u32 v11, v1, 3, 2
  v_lshl_add_u32 v2, v11, 10, v10
  v_lshl_add_u32 v2, v9, 14, v2
  s_lshl_b32 s6, s7, 15
  v_add_u32 v2, s6, v2
  v_xor_b32 v3, 64, v2
  v_add_u32 v3, 4096, v3
  s_lshl_b32 s9, s7, 10
  s_and_b32 s6, s7, 1
  s_lshl_b32 s6, s6, 6
  v_xor_b32 v4, s6, v10
  v_lshrrev_b32 v11, 3, v1
  v_lshl_add_u32 v4, v11, 10, v4
  s_lshl_b32 s6, s7, 13
  v_add_u32 v4, s6, v4
  v_lshrrev_b32 v10, 2, v1
  s_lshl_b32 s6, s7, 4
  v_add_u32 v10, s6, v10
  v_mul_u32_u24 v5, 2752, v10
  s_lshr_b32 s11, s5, 2
  s_mul_i32 s6, s5, 3
  s_sub_u32 s6, s6, s11
  s_lshl_b32 s6, s6, 6
  v_add_u32 v5, s6, v5
  v_and_b32 v10, 3, v1
  v_lshl_add_u32 v5, v10, 4, v5
  v_xor_b32 v16, 32, v5
  s_mul_i32 s10, s7, 6144
  s_cmp_ge_u32 s5, 15
  s_cselect_b32 s92, 0x40000000, 0
  s_and_b32 s93, s5, 3
  s_cmp_eq_u32 s93, 3
  s_cselect_b32 s93, 0x40000000, 0
  s_lshl_b32 s6, s4, 17
  s_lshl_b32 s13, s5, 15
  s_waitcnt lgkmcnt(0)
  s_add_u32 s44, s16, s6
  s_addc_u32 s45, s17, 0
  s_mov_b32 s46, 0x20000
  s_mov_b32 s47, 0x20000
  s_add_u32 s11, s83, 0
  s_and_b32 s11, s11, 7
  s_lshl_b32 s11, s11, 7
  s_add_u32 s12, s11, 8192
  s_add_u32 m0, s8, 98304
  s_nop 0
  buffer_load_dwordx4 v2, s[44:47], s11 offen lds
  s_add_u32 m0, s8, 99328
  s_nop 0
  buffer_load_dwordx4 v3, s[44:47], s11 offen lds
  s_add_u32 m0, s8, 100352
  s_nop 0
  buffer_load_dwordx4 v2, s[44:47], s12 offen lds
  s_add_u32 m0, s8, 101376
  s_nop 0
  buffer_load_dwordx4 v3, s[44:47], s12 offen lds
  s_add_u32 s48, s22, s13
  s_addc_u32 s49, s23, 0
  s_mov_b32 s50, 0x8000
  s_mov_b32 s51, 0x20000
  s_add_u32 s52, s24, s13
  s_addc_u32 s53, s25, 0
  s_mov_b32 s54, 0x8000
  s_mov_b32 s55, 0x20000
  s_add_u32 m0, s9, 114688
  s_nop 0
  buffer_load_dwordx4 v4, s[48:51], s11 offen lds
  s_add_u32 m0, s9, 118784
  s_nop 0
  buffer_load_dwordx4 v4, s[52:55], s11 offen lds
  s_lshl_b32 s6, s5, 3
  s_lshl_b32 s13, s7, 1
  s_add_u32 s13, s13, s6
  s_lshl_b32 s6, s13, 10
  v_lshlrev_b32 v17, 4, v8
  v_lshl_add_u32 v18, v9, 10, v17
  v_add_u32 v18, s6, v18
  buffer_load_dwordx4 v[64:67], v18, s[44:47], 0 offen
  buffer_load_dwordx4 v[68:71], v18, s[44:47], 0 offen offset:512
  global_load_dwordx4 v[72:75], v17, s[38:39]
  global_load_dwordx4 v[76:79], v17, s[38:39] offset:512
  s_and_b32 s6, s4, 8
  s_lshl_b32 s6, s6, 4
  s_add_u32 s6, s6, 0xa31000
  s_add_u32 s88, s42, s6
  s_addc_u32 s89, s43, 0
  s_mov_b32 s90, 0x4
  s_mov_b32 s91, 0x20000
  v_mov_b32 v88, 0
  buffer_load_dword v87, v88, s[88:91], 0 offen sc1
  s_add_u32 s11, s83, 1
  s_and_b32 s11, s11, 7
  s_lshl_b32 s11, s11, 7
  s_add_u32 s12, s11, 8192
  s_add_u32 m0, s8, 0
  s_nop 0
  buffer_load_dwordx4 v2, s[44:47], s11 offen lds
  s_add_u32 m0, s8, 1024
  s_nop 0
  buffer_load_dwordx4 v3, s[44:47], s11 offen lds
  s_add_u32 m0, s8, 2048
  s_nop 0
  buffer_load_dwordx4 v2, s[44:47], s12 offen lds
  s_add_u32 m0, s8, 3072
  s_nop 0
  buffer_load_dwordx4 v3, s[44:47], s12 offen lds
  s_add_u32 m0, s9, 16384
  s_nop 0
  buffer_load_dwordx4 v4, s[48:51], s11 offen lds
  s_add_u32 m0, s9, 20480
  s_nop 0
  buffer_load_dwordx4 v4, s[52:55], s11 offen lds
  s_mov_b32 s56, s32
  s_mov_b32 s57, s33
  s_mov_b32 s58, 0x158000
  s_mov_b32 s59, 0x20000
  s_mov_b32 s60, s34
  s_mov_b32 s61, s35
  s_mov_b32 s62, 0x158000
  s_mov_b32 s63, 0x20000
  s_mov_b32 s80, 0xbfb8aa3b
  v_bfe_u32 v10, v1, 1, 3
  v_xor_b32 v10, v10, v9
  v_lshlrev_b32 v10, 4, v10
  v_lshl_add_u32 v7, v8, 7, v10
  v_bfe_u32 v10, v1, 4, 1
  v_mul_u32_u24 v12, 3104, v10
  v_lshlrev_b32 v11, 9, v9
  v_add_u32 v12, v12, v11
  v_bfe_u32 v11, v1, 2, 2
  v_lshl_add_u32 v12, v11, 6, v12
  v_and_b32 v11, 3, v1
  v_lshl_add_u32 v12, v11, 3, v12
  v_xor_b32 v13, 32, v12
  v_lshlrev_b32 v6, 4, v1
  s_lshl_b32 s6, s4, 2
  s_add_u32 s6, s6, s7
  s_mul_i32 s81, s6, 153600
  s_lshr_b32 s82, s5, 2
  s_mul_i32 s6, s5, 3
  s_sub_u32 s6, s6, s82
  s_lshl_b32 s6, s6, 11
  s_add_u32 s82, s81, s6
  s_mov_b32 s64, s42
  s_mov_b32 s65, s43
  s_mov_b32 s66, 0x960000
  s_mov_b32 s67, 0x20000
  s_add_u32 s76, s42, 0xa20000
  s_addc_u32 s77, s43, 0
  s_mov_b32 s78, 0x4000
  s_mov_b32 s79, 0x20000
  v_add_u32 v7, s8, v7
  s_add_u32 s82, s82, 67584
  s_add_u32 s87, s82, s93
  s_add_u32 s82, s82, s92
  s_branch L_Fmain
L_S:
  s_lshl_b32 s6, s5, 6
  v_lshlrev_b32 v4, 1, v8
  v_add_u32 v4, s6, v4
  v_mov_b32 v55, 0
  s_lshr_b32 s6, s2, 3
  s_lshl_b32 s6, s6, 2
  s_add_u32 s6, s6, s7
  s_lshl_b32 s6, s6, 9
  v_and_b32 v53, 3, v1
  v_lshl_add_u32 v53, v53, 7, s6
  v_min_u32 v53, L_code_end - gated_mix__ssm_conv_s5__glu_gated_swiglu__prompt_kernel - 4, v53
  s_getpc_b64 s[44:45]
L_pc:
  s_sub_u32 s44, s44, L_pc - gated_mix__ssm_conv_s5__glu_gated_swiglu__prompt_kernel
  s_subb_u32 s45, s45, 0
  v_mov_b32 v51, s45
  v_add_co_u32 v50, vcc, s44, v53
  s_nop 1
  v_addc_co_u32 v51, vcc, 0, v51, vcc
  s_mov_b64 exec, 15
  global_load_dword v52, v[50:51], off
  s_mov_b64 exec, -1
  s_lshl_b32 s6, s5, 7
  s_add_u32 s6, s6, 0xa30000
  s_waitcnt lgkmcnt(0)
  global_load_ushort v60, v4, s[18:19]
  global_load_ushort v61, v4, s[20:21]
  global_load_ushort v62, v4, s[30:31]
  s_add_u32 s72, s42, s6
  s_addc_u32 s73, s43, 0
  s_mov_b32 s74, 0x4
  s_mov_b32 s75, 0x20000
  buffer_load_dword v54, v55, s[72:75], 0 offen sc1
  s_and_b32 s6, s4, 8
  s_lshl_b32 s6, s6, 4
  s_add_u32 s6, s6, 0xa31000
  s_add_u32 s76, s42, s6
  s_addc_u32 s77, s43, 0
  s_mov_b32 s78, 0x4
  s_mov_b32 s79, 0x20000
  buffer_load_dword v56, v55, s[76:79], 0 offen sc1
  s_mov_b32 s80, 0xbfb8aa3b
  v_bfe_u32 v10, v1, 1, 3
  v_xor_b32 v10, v10, v9
  v_lshlrev_b32 v10, 4, v10
  v_lshl_add_u32 v7, v8, 7, v10
  v_bfe_u32 v10, v1, 4, 1
  v_mul_u32_u24 v12, 3104, v10
  v_lshlrev_b32 v11, 9, v9
  v_add_u32 v12, v12, v11
  v_bfe_u32 v11, v1, 2, 2
  v_lshl_add_u32 v12, v11, 6, v12
  v_and_b32 v11, 3, v1
  v_lshl_add_u32 v12, v11, 3, v12
  v_xor_b32 v13, 32, v12
  v_lshlrev_b32 v6, 4, v1
  s_lshl_b32 s6, s4, 2
  s_add_u32 s6, s6, s7
  s_mul_i32 s81, s6, 153600
  s_lshr_b32 s82, s5, 2
  s_mul_i32 s6, s5, 3
  s_sub_u32 s6, s6, s82
  s_lshl_b32 s6, s6, 11
  s_add_u32 s82, s81, s6
  s_mov_b32 s64, s42
  s_mov_b32 s65, s43
  s_mov_b32 s66, 0x960000
  s_mov_b32 s67, 0x20000
  s_mul_i32 s10, s7, 6144
  s_cmp_ge_u32 s5, 15
  s_cselect_b32 s92, 0x40000000, 0
  s_and_b32 s93, s5, 3
  s_cmp_eq_u32 s93, 3
  s_cselect_b32 s93, 0x40000000, 0
  s_mov_b32 s56, s32
  s_mov_b32 s57, s33
  s_mov_b32 s58, 0x158000
  s_mov_b32 s59, 0x20000
  s_mov_b32 s60, s34
  s_mov_b32 s61, s35
  s_mov_b32 s62, 0x158000
  s_mov_b32 s63, 0x20000
  s_lshl_b32 s6, s5, 13
  s_add_u32 s6, s6, 0xa00000
  s_add_u32 s68, s42, s6
  s_addc_u32 s69, s43, 0
  s_mov_b32 s70, 0x2000
  s_mov_b32 s71, 0x20000
  s_and_b32 s6, s4, 8
  s_lshl_b32 s6, s6, 9
  s_add_u32 s6, s6, 0xa40000
  s_add_u32 s88, s42, s6
  s_addc_u32 s89, s43, 0
  s_mov_b32 s90, 0x1000
  s_mov_b32 s91, 0x20000
  s_and_b32 s87, s4, 7
  s_lshl_b32 s87, s87, 7
  s_add_u32 s87, s87, s5
  s_lshl_b32 s87, s87, 2
  s_mov_b32 s48, s26
  s_mov_b32 s49, s27
  s_mov_b32 s50, 0x80000
  s_mov_b32 s51, 0x20000
  s_mov_b32 s52, s28
  s_mov_b32 s53, s29
  s_mov_b32 s54, 0x80000
  s_mov_b32 s55, 0x20000
  s_mov_b32 s44, s36
  s_mov_b32 s45, s37
  s_mov_b32 s46, 0x158000
  s_mov_b32 s47, 0x20000
  s_add_u32 s82, s82, 65536
  s_lshl_b32 s100, s5, 11
  s_add_u32 s100, s100, s81
  s_add_u32 s101, s100, 32768
  v_lshlrev_b32 v4, 3, v0
  v_add_u32 v4, 149504, v4
  v_mov_b32 v48, 0
  v_mov_b32 v49, 0
  ds_write_b64 v4, v[48:49]
  ds_write_b32 v4, v48 offset:2048
  s_lshl_b32 s6, s7, 1
  v_add_u32 v63, s6, v9
  v_sub_u32 v4, 7, v63
  v_lshlrev_b32 v4, 8, v4
  v_lshl_add_u32 v4, v8, 3, v4
  v_add_u32 v4, 147456, v4
  v_lshlrev_b32 v63, 4, v63
  v_cvt_f32_u32 v63, v63
  s_lshl_b32 s6, s7, 9
  v_lshlrev_b32 v57, 7, v9
  v_add_u32 v57, s6, v57
  v_cvt_f32_u32 v57, v57
  s_waitcnt lgkmcnt(0)
  s_lshr_b32 s6, s2, 3
  s_mul_i32 s30, s6, 43
  s_lshr_b32 s30, s30, 8
  s_mul_i32 s30, s30, 6
  s_sub_u32 s30, s6, s30
  s_lshr_b32 s9, s5, 3
  s_lshl_b32 s9, s9, 18
  s_lshl_b32 s15, s6, 13
  s_add_u32 s9, s9, s15
  s_lshl_b32 s15, s7, 11
  s_add_u32 s9, s9, s15
  s_mul_i32 s15, s6, 43
  s_mul_i32 s6, s7, 11
  s_add_u32 s15, s15, s6
  s_lshl_b32 s15, s15, 1
  s_lshr_b32 s6, s5, 3
  s_add_u32 s15, s15, s6
  s_lshl_b32 s15, s15, 9
  s_bfe_u32 s6, s2, 0x10002
  s_lshl_b32 s6, s6, 1
  s_and_b32 s30, s2, 1
  s_add_u32 s30, s30, s6
  s_sub_u32 s30, s30, s7
  v_add_u32 v28, 98304, v7
  v_xor_b32 v29, 32, v28
  v_xor_b32 v30, 64, v28
  v_xor_b32 v31, 0x60, v28
  v_add_u32 v24, s8, v28
  v_add_u32 v25, s8, v29
  v_add_u32 v26, s8, v30
  v_add_u32 v27, s8, v31
  s_barrier
  ds_read_b128 a[0:3], v24
  ds_read_b128 v[32:35], v28 offset:16384
  ds_read_b128 v[36:39], v28 offset:20480
  ds_read_b128 a[4:7], v25
  ds_read_b128 v[40:43], v29 offset:16384
  ds_read_b128 v[44:47], v29 offset:20480
  s_waitcnt lgkmcnt(4)
  v_mfma_f32_32x32x16_bf16 v[64:79], a[0:3], v[32:35], 0
  s_waitcnt vmcnt(0)
  v_readfirstlane_b32 s14, v54
  v_readfirstlane_b32 s86, v56
  s_add_u32 s14, s14, 1
  s_bitset1_b32 s14, 31
  s_add_u32 s86, s86, 1
  s_bitset1_b32 s86, 31
  v_lshlrev_b32 v60, 16, v60
  v_lshlrev_b32 v61, 16, v61
  v_lshlrev_b32 v62, 16, v62
  v_mul_f32 v62, 0x3fb8aa3b, v62
  v_exp_f32 v62, v62
  s_nop 0
  v_cvt_pk_bf16_f32 v62, v62, v62
  v_and_b32 v62, 0xffff0000, v62
  v_mul_f32 v50, v62, v60
  s_waitcnt lgkmcnt(3)
  v_mfma_f32_32x32x16_bf16 v[80:95], a[0:3], v[36:39], 0
  ds_read_b128 a[8:11], v26
  ds_read_b128 v[32:35], v30 offset:16384
  v_mul_f32 v51, v62, v61
  v_mul_f32 v50, 0x3fb8aa3b, v50
  v_mul_f32 v51, 0x3e22f983, v51
  v_exp_f32 v52, v50
  v_fract_f32 v53, v51
  v_cos_f32 v16, v53
  v_sin_f32 v17, v53
  s_nop 0
  v_mul_f32 v16, v16, v52
  v_mul_f32 v17, v17, v52
  v_mul_f32 v52, 0x41800000, v50
  v_mul_f32 v53, 0x41800000, v51
  v_exp_f32 v52, v52
  v_fract_f32 v53, v53
  v_cos_f32 v18, v53
  v_sin_f32 v19, v53
  s_waitcnt lgkmcnt(3)
  v_mfma_f32_32x32x16_bf16 v[64:79], a[4:7], v[40:43], v[64:79]
  ds_read_b128 v[36:39], v30 offset:20480
  s_nop 0
  v_mul_f32 v18, v18, v52
  v_mul_f32 v19, v19, v52
  v_mul_f32 v52, v57, v50
  v_mul_f32 v53, v57, v51
  v_exp_f32 v52, v52
  v_fract_f32 v53, v53
  v_cos_f32 v20, v53
  v_sin_f32 v21, v53
  s_nop 0
  v_mul_f32 v20, v20, v52
  v_mul_f32 v21, v21, v52
  v_mul_f32 v52, 0x43800000, v50
  v_mul_f32 v53, 0x43800000, v51
  v_exp_f32 v52, v52
  v_fract_f32 v53, v53
  s_waitcnt lgkmcnt(3)
  v_mfma_f32_32x32x16_bf16 v[80:95], a[4:7], v[44:47], v[80:95]
  ds_read_b128 a[12:15], v27
  ds_read_b128 v[40:43], v31 offset:16384
  v_cos_f32 v22, v53
  v_sin_f32 v23, v53
  s_nop 0
  v_mul_f32 v22, v22, v52
  v_mul_f32 v23, v23, v52
  v_mul_f32 v52, v63, v50
  v_mul_f32 v53, v63, v51
  v_exp_f32 v52, v52
  v_fract_f32 v53, v53
  v_cos_f32 v10, v53
  v_sin_f32 v11, v53
  s_nop 0
  v_mul_f32 v10, v10, v52
  v_mul_f32 v11, v11, v52
  v_sub_f32 v5, 0, v17
  v_mul_f32 v52, v60, v60
  s_waitcnt lgkmcnt(3)
  v_mfma_f32_32x32x16_bf16 v[64:79], a[8:11], v[32:35], v[64:79]
  ds_read_b128 v[44:47], v31 offset:20480
  v_fmac_f32 v52, v61, v61
  v_rcp_f32 v52, v52
  v_add_f32 v53, -1.0, v16
  v_mul_f32 v2, v53, v60
  v_fmac_f32 v2, v17, v61
  v_mul_f32 v3, v17, v60
  v_fma_f32 v3, -v53, v61, v3
  v_add_f32 v52, v52, v52
  v_mul_f32 v2, v2, v52
  v_mul_f32 v3, v3, v52
  v_lshlrev_b32 v54, 5, v8
  v_lshl_add_u32 v54, v9, 4, v54
  v_xor_b32 v55, 0x80, v54
  s_lshl_b32 s6, s7, 2
  s_sub_u32 s6, s6, s4
  s_add_u32 s6, s6, 16
  s_waitcnt lgkmcnt(3)
  v_mfma_f32_32x32x16_bf16 v[80:95], a[8:11], v[36:39], v[80:95]
  v_add_u32 v28, 0, v7
  v_xor_b32 v29, 32, v28
  v_xor_b32 v30, 64, v28
  v_xor_b32 v31, 0x60, v28
  v_add_u32 v24, s8, v28
  v_add_u32 v25, s8, v29
  v_add_u32 v26, s8, v30
  v_add_u32 v27, s8, v31
  s_barrier
  ds_read_b128 a[16:19], v24
  ds_read_b128 v[32:35], v28 offset:16384
  v_add_u32 v62, s6, v9
  v_lshlrev_b32 v60, 9, v62
  v_lshl_add_u32 v60, v8, 4, v60
  v_sub_u32 v62, 17, v62
  v_and_b32 v62, -2, v62
  v_max_i32 v62, 0, v62
  v_min_i32 v62, 4, v62
  v_lshlrev_b32 v63, 3, v8
  v_add_u32 v63, 155648, v63
  s_lshl_b32 s6, s7, 9
  v_lshl_add_u32 v61, v9, 8, v63
  v_add_u32 v61, s6, v61
  s_waitcnt lgkmcnt(3)
  v_mfma_f32_32x32x16_bf16 v[64:79], a[12:15], v[40:43], v[64:79]
  ds_read_b128 v[36:39], v28 offset:20480
  s_waitcnt lgkmcnt(3)
  v_mfma_f32_32x32x16_bf16 v[80:95], a[12:15], v[44:47], v[80:95]
  ds_read_b128 a[20:23], v25
  ds_read_b128 v[40:43], v29 offset:16384
  s_waitcnt lgkmcnt(3)
  v_mfma_f32_32x32x16_bf16 v[64:79], a[16:19], v[32:35], v[64:79]
  ds_read_b128 v[44:47], v29 offset:20480
  s_waitcnt lgkmcnt(3)
  v_mfma_f32_32x32x16_bf16 v[80:95], a[16:19], v[36:39], v[80:95]
  ds_read_b128 a[24:27], v26
  ds_read_b128 v[32:35], v30 offset:16384
  s_waitcnt lgkmcnt(3)
  v_mfma_f32_32x32x16_bf16 v[64:79], a[20:23], v[40:43], v[64:79]
  ds_read_b128 v[36:39], v30 offset:20480
  s_waitcnt lgkmcnt(3)
  v_mfma_f32_32x32x16_bf16 v[80:95], a[20:23], v[44:47], v[80:95]
  ds_read_b128 a[28:31], v27
  ds_read_b128 v[40:43], v31 offset:16384
  s_waitcnt lgkmcnt(3)
  v_mfma_f32_32x32x16_bf16 v[64:79], a[24:27], v[32:35], v[64:79]
  ds_read_b128 v[44:47], v31 offset:20480
  s_waitcnt lgkmcnt(3)
  v_mfma_f32_32x32x16_bf16 v[80:95], a[24:27], v[36:39], v[80:95]
  v_add_u32 v28, 122880, v7
  v_xor_b32 v29, 32, v28
  v_xor_b32 v30, 64, v28
  v_xor_b32 v31, 0x60, v28
  v_add_u32 v24, s8, v28
  v_add_u32 v25, s8, v29
  v_add_u32 v26, s8, v30
  v_add_u32 v27, s8, v31
  s_barrier
  s_cmp_lg_u32 s30, 0
  s_cbranch_scc1 L_spf0
  v_lshlrev_b32 v58, 7, v1
  s_mov_b64 exec, 0xffff
  buffer_load_dword v59, v58, s[48:51], s9 offen
  buffer_load_dword v59, v58, s[52:55], s9 offen
  s_mov_b64 exec, -1
  v_lshrrev_b32 v58, 2, v1
  v_lshlrev_b32 v58, 3, v58
  v_and_or_b32 v58, v1, 3, v58
  v_lshlrev_b32 v58, 7, v58
  s_mov_b32 exec_hi, 0xfff
  buffer_load_dword v59, v58, s[44:47], s15 offen
  s_mov_b64 exec, -1
L_spf0:
  ds_read_b128 a[32:35], v24
  ds_read_b128 v[32:35], v28 offset:16384
  s_waitcnt lgkmcnt(3)
  v_mfma_f32_32x32x16_bf16 v[64:79], a[28:31], v[40:43], v[64:79]
  ds_read_b128 v[36:39], v28 offset:20480
  s_waitcnt lgkmcnt(3)
  v_mfma_f32_32x32x16_bf16 v[80:95], a[28:31], v[44:47], v[80:95]
  ds_read_b128 a[36:39], v25
  ds_read_b128 v[40:43], v29 offset:16384
  s_waitcnt lgkmcnt(3)
  v_mfma_f32_32x32x16_bf16 v[64:79], a[32:35], v[32:35], v[64:79]
  ds_read_b128 v[44:47], v29 offset:20480
  s_waitcnt lgkmcnt(3)
  v_mfma_f32_32x32x16_bf16 v[80:95], a[32:35], v[36:39], v[80:95]
  ds_read_b128 a[40:43], v26
  ds_read_b128 v[32:35], v30 offset:16384
  s_waitcnt lgkmcnt(3)
  v_mfma_f32_32x32x16_bf16 v[64:79], a[36:39], v[40:43], v[64:79]
  ds_read_b128 v[36:39], v30 offset:20480
  s_waitcnt lgkmcnt(3)
  v_mfma_f32_32x32x16_bf16 v[80:95], a[36:39], v[44:47], v[80:95]
  ds_read_b128 a[44:47], v27
  ds_read_b128 v[40:43], v31 offset:16384
  s_waitcnt lgkmcnt(3)
  v_mfma_f32_32x32x16_bf16 v[64:79], a[40:43], v[32:35], v[64:79]
  ds_read_b128 v[44:47], v31 offset:20480
  s_waitcnt lgkmcnt(3)
  v_mfma_f32_32x32x16_bf16 v[80:95], a[40:43], v[36:39], v[80:95]
  v_add_u32 v28, 24576, v7
  v_xor_b32 v29, 32, v28
  v_xor_b32 v30, 64, v28
  v_xor_b32 v31, 0x60, v28
  v_add_u32 v24, s8, v28
  v_add_u32 v25, s8, v29
  v_add_u32 v26, s8, v30
  v_add_u32 v27, s8, v31
  s_barrier
  ds_read_b128 a[48:51], v24
  ds_read_b128 v[32:35], v28 offset:16384
  s_waitcnt lgkmcnt(3)
  v_mfma_f32_32x32x16_bf16 v[64:79], a[44:47], v[40:43], v[64:79]
  ds_read_b128 v[36:39], v28 offset:20480
  s_waitcnt lgkmcnt(3)
  v_mfma_f32_32x32x16_bf16 v[80:95], a[44:47], v[44:47], v[80:95]
  ds_read_b128 a[52:55], v25
  ds_read_b128 v[40:43], v29 offset:16384
  s_waitcnt lgkmcnt(3)
  v_mfma_f32_32x32x16_bf16 v[64:79], a[48:51], v[32:35], v[64:79]
  ds_read_b128 v[44:47], v29 offset:20480
  s_waitcnt lgkmcnt(3)
  v_mfma_f32_32x32x16_bf16 v[80:95], a[48:51], v[36:39], v[80:95]
  ds_read_b128 a[56:59], v26
  ds_read_b128 v[32:35], v30 offset:16384
  s_waitcnt lgkmcnt(3)
  v_mfma_f32_32x32x16_bf16 v[64:79], a[52:55], v[40:43], v[64:79]
  ds_read_b128 v[36:39], v30 offset:20480
  s_waitcnt lgkmcnt(3)
  v_mfma_f32_32x32x16_bf16 v[80:95], a[52:55], v[44:47], v[80:95]
  ds_read_b128 a[60:63], v27
  ds_read_b128 v[40:43], v31 offset:16384
  s_waitcnt lgkmcnt(3)
  v_mfma_f32_32x32x16_bf16 v[64:79], a[56:59], v[32:35], v[64:79]
  ds_read_b128 v[44:47], v31 offset:20480
  s_waitcnt lgkmcnt(3)
  v_mfma_f32_32x32x16_bf16 v[80:95], a[56:59], v[36:39], v[80:95]
  v_add_u32 v28, 98304, v7
  v_xor_b32 v29, 32, v28
  v_xor_b32 v30, 64, v28
  v_xor_b32 v31, 0x60, v28
  v_add_u32 v24, s8, v28
  v_add_u32 v25, s8, v29
  v_add_u32 v26, s8, v30
  v_add_u32 v27, s8, v31
  s_barrier
  ds_read_b128 a[64:67], v24
  ds_read_b128 v[32:35], v28 offset:16384
  s_waitcnt lgkmcnt(3)
  v_mfma_f32_32x32x16_bf16 v[64:79], a[60:63], v[40:43], v[64:79]
  ds_read_b128 v[36:39], v28 offset:20480
  s_waitcnt lgkmcnt(3)
  v_mfma_f32_32x32x16_bf16 v[80:95], a[60:63], v[44:47], v[80:95]
  ds_read_b128 a[68:71], v25
  ds_read_b128 v[40:43], v29 offset:16384
  s_waitcnt lgkmcnt(3)
  v_mfma_f32_32x32x16_bf16 v[64:79], a[64:67], v[32:35], v[64:79]
  ds_read_b128 v[44:47], v29 offset:20480
  s_waitcnt lgkmcnt(3)
  v_mfma_f32_32x32x16_bf16 v[80:95], a[64:67], v[36:39], v[80:95]
  ds_read_b128 a[72:75], v26
  ds_read_b128 v[32:35], v30 offset:16384
  s_waitcnt lgkmcnt(3)
  v_mfma_f32_32x32x16_bf16 v[64:79], a[68:71], v[40:43], v[64:79]
  ds_read_b128 v[36:39], v30 offset:20480
  s_waitcnt lgkmcnt(3)
  v_mfma_f32_32x32x16_bf16 v[80:95], a[68:71], v[44:47], v[80:95]
  ds_read_b128 a[76:79], v27
  ds_read_b128 v[40:43], v31 offset:16384
  s_waitcnt lgkmcnt(3)
  v_mfma_f32_32x32x16_bf16 v[64:79], a[72:75], v[32:35], v[64:79]
  ds_read_b128 v[44:47], v31 offset:20480
  s_waitcnt lgkmcnt(3)
  v_mfma_f32_32x32x16_bf16 v[80:95], a[72:75], v[36:39], v[80:95]
  v_add_u32 v28, 0, v7
  v_xor_b32 v29, 32, v28
  v_xor_b32 v30, 64, v28
  v_xor_b32 v31, 0x60, v28
  v_add_u32 v24, s8, v28
  v_add_u32 v25, s8, v29
  v_add_u32 v26, s8, v30
  v_add_u32 v27, s8, v31
  s_barrier
  ds_read_b128 a[80:83], v24
  ds_read_b128 v[32:35], v28 offset:16384
  s_waitcnt lgkmcnt(3)
  v_mfma_f32_32x32x16_bf16 v[64:79], a[76:79], v[40:43], v[64:79]
  ds_read_b128 v[36:39], v28 offset:20480
  s_waitcnt lgkmcnt(3)
  v_mfma_f32_32x32x16_bf16 v[80:95], a[76:79], v[44:47], v[80:95]
  ds_read_b128 a[84:87], v25
  ds_read_b128 v[40:43], v29 offset:16384
  s_waitcnt lgkmcnt(3)
  v_mfma_f32_32x32x16_bf16 v[64:79], a[80:83], v[32:35], v[64:79]
  ds_read_b128 v[44:47], v29 offset:20480
  s_waitcnt lgkmcnt(3)
  v_mfma_f32_32x32x16_bf16 v[80:95], a[80:83], v[36:39], v[80:95]
  ds_read_b128 a[88:91], v26
  ds_read_b128 v[32:35], v30 offset:16384
  s_waitcnt lgkmcnt(3)
  v_mfma_f32_32x32x16_bf16 v[64:79], a[84:87], v[40:43], v[64:79]
  ds_read_b128 v[36:39], v30 offset:20480
  s_waitcnt lgkmcnt(3)
  v_mfma_f32_32x32x16_bf16 v[80:95], a[84:87], v[44:47], v[80:95]
  ds_read_b128 a[92:95], v27
  ds_read_b128 v[40:43], v31 offset:16384
  s_waitcnt lgkmcnt(3)
  v_mfma_f32_32x32x16_bf16 v[64:79], a[88:91], v[32:35], v[64:79]
  ds_read_b128 v[44:47], v31 offset:20480
  s_waitcnt lgkmcnt(3)
  v_mfma_f32_32x32x16_bf16 v[80:95], a[88:91], v[36:39], v[80:95]
  v_add_u32 v28, 122880, v7
  v_xor_b32 v29, 32, v28
  v_xor_b32 v30, 64, v28
  v_xor_b32 v31, 0x60, v28
  v_add_u32 v24, s8, v28
  v_add_u32 v25, s8, v29
  v_add_u32 v26, s8, v30
  v_add_u32 v27, s8, v31
  s_barrier
  ds_read_b128 a[96:99], v24
  ds_read_b128 v[32:35], v28 offset:16384
  s_waitcnt lgkmcnt(3)
  v_mfma_f32_32x32x16_bf16 v[64:79], a[92:95], v[40:43], v[64:79]
  ds_read_b128 v[36:39], v28 offset:20480
  s_waitcnt lgkmcnt(3)
  v_mfma_f32_32x32x16_bf16 v[80:95], a[92:95], v[44:47], v[80:95]
  ds_read_b128 a[100:103], v25
  ds_read_b128 v[40:43], v29 offset:16384
  s_waitcnt lgkmcnt(3)
  v_mfma_f32_32x32x16_bf16 v[64:79], a[96:99], v[32:35], v[64:79]
  ds_read_b128 v[44:47], v29 offset:20480
  s_waitcnt lgkmcnt(3)
  v_mfma_f32_32x32x16_bf16 v[80:95], a[96:99], v[36:39], v[80:95]
  ds_read_b128 a[104:107], v26
  ds_read_b128 v[32:35], v30 offset:16384
  s_waitcnt lgkmcnt(3)
  v_mfma_f32_32x32x16_bf16 v[64:79], a[100:103], v[40:43], v[64:79]
  ds_read_b128 v[36:39], v30 offset:20480
  s_waitcnt lgkmcnt(3)
  v_mfma_f32_32x32x16_bf16 v[80:95], a[100:103], v[44:47], v[80:95]
  ds_read_b128 a[108:111], v27
  ds_read_b128 v[40:43], v31 offset:16384
  s_waitcnt lgkmcnt(3)
  v_mfma_f32_32x32x16_bf16 v[64:79], a[104:107], v[32:35], v[64:79]
  ds_read_b128 v[44:47], v31 offset:20480
  s_waitcnt lgkmcnt(3)
  v_mfma_f32_32x32x16_bf16 v[80:95], a[104:107], v[36:39], v[80:95]
  v_add_u32 v28, 24576, v7
  v_xor_b32 v29, 32, v28
  v_xor_b32 v30, 64, v28
  v_xor_b32 v31, 0x60, v28
  v_add_u32 v24, s8, v28
  v_add_u32 v25, s8, v29
  v_add_u32 v26, s8, v30
  v_add_u32 v27, s8, v31
  s_barrier
  ds_read_b128 a[112:115], v24
  ds_read_b128 v[32:35], v28 offset:16384
  s_waitcnt lgkmcnt(3)
  v_mfma_f32_32x32x16_bf16 v[64:79], a[108:111], v[40:43], v[64:79]
  ds_read_b128 v[36:39], v28 offset:20480
  s_waitcnt lgkmcnt(3)
  v_mfma_f32_32x32x16_bf16 v[80:95], a[108:111], v[44:47], v[80:95]
  ds_read_b128 a[116:119], v25
  ds_read_b128 v[40:43], v29 offset:16384
  s_waitcnt lgkmcnt(3)
  v_mfma_f32_32x32x16_bf16 v[64:79], a[112:115], v[32:35], v[64:79]
  ds_read_b128 v[44:47], v29 offset:20480
  s_waitcnt lgkmcnt(3)
  v_mfma_f32_32x32x16_bf16 v[80:95], a[112:115], v[36:39], v[80:95]
  ds_read_b128 a[120:123], v26
  ds_read_b128 v[32:35], v30 offset:16384
  s_waitcnt lgkmcnt(3)
  v_mfma_f32_32x32x16_bf16 v[64:79], a[116:119], v[40:43], v[64:79]
  ds_read_b128 v[36:39], v30 offset:20480
  s_waitcnt lgkmcnt(3)
  v_mfma_f32_32x32x16_bf16 v[80:95], a[116:119], v[44:47], v[80:95]
  ds_read_b128 a[124:127], v27
  ds_read_b128 v[40:43], v31 offset:16384
  s_waitcnt lgkmcnt(3)
  v_mfma_f32_32x32x16_bf16 v[64:79], a[120:123], v[32:35], v[64:79]
  ds_read_b128 v[44:47], v31 offset:20480
  s_waitcnt lgkmcnt(3)
  v_mfma_f32_32x32x16_bf16 v[80:95], a[120:123], v[36:39], v[80:95]
  s_waitcnt lgkmcnt(1)
  v_mfma_f32_32x32x16_bf16 v[64:79], a[124:127], v[40:43], v[64:79]
  s_waitcnt lgkmcnt(0)
  v_mfma_f32_32x32x16_bf16 v[80:95], a[124:127], v[44:47], v[80:95]
  s_waitcnt vmcnt(0)
  s_nop 7
  s_nop 3
  v_fma_f32 v50, v16, v64, v65
  v_fma_f32 v51, v16, v80, v81
  v_fma_f32 v50, -v17, v80, v50
  v_fma_f32 v51, v17, v64, v51
  v_fma_f32 v48, v16, v50, v66
  v_fma_f32 v49, v16, v51, v82
  v_fma_f32 v48, -v17, v51, v48
  v_fma_f32 v49, v17, v50, v49
  v_fma_f32 v50, v16, v48, v67
  v_fma_f32 v51, v16, v49, v83
  v_fma_f32 v50, -v17, v49, v50
  v_fma_f32 v51, v17, v48, v51
  v_fma_f32 v48, v16, v50, v68
  v_fma_f32 v49, v16, v51, v84
  v_fma_f32 v48, -v17, v51, v48
  v_fma_f32 v49, v17, v50, v49
  v_fma_f32 v50, v16, v48, v69
  v_fma_f32 v51, v16, v49, v85
  v_fma_f32 v50, -v17, v49, v50
  v_fma_f32 v51, v17, v48, v51
  v_fma_f32 v48, v16, v50, v70
  v_fma_f32 v49, v16, v51, v86
  v_fma_f32 v48, -v17, v51, v48
  v_fma_f32 v49, v17, v50, v49
  v_fma_f32 v50, v16, v48, v71
  v_fma_f32 v51, v16, v49, v87
  v_fma_f32 v50, -v17, v49, v50
  v_fma_f32 v51, v17, v48, v51
  v_fma_f32 v48, v16, v50, v72
  v_fma_f32 v49, v16, v51, v88
  v_fma_f32 v48, -v17, v51, v48
  v_fma_f32 v49, v17, v50, v49
  v_fma_f32 v50, v16, v48, v73
  v_fma_f32 v51, v16, v49, v89
  v_fma_f32 v50, -v17, v49, v50
  v_fma_f32 v51, v17, v48, v51
  v_fma_f32 v48, v16, v50, v74
  v_fma_f32 v49, v16, v51, v90
  v_fma_f32 v48, -v17, v51, v48
  v_fma_f32 v49, v17, v50, v49
  v_fma_f32 v50, v16, v48, v75
  v_fma_f32 v51, v16, v49, v91
  v_fma_f32 v50, -v17, v49, v50
  v_fma_f32 v51, v17, v48, v51
  v_fma_f32 v48, v16, v50, v76
  v_fma_f32 v49, v16, v51, v92
  v_fma_f32 v48, -v17, v51, v48
  v_fma_f32 v49, v17, v50, v49
  v_fma_f32 v50, v16, v48, v77
  v_fma_f32 v51, v16, v49, v93
  v_fma_f32 v50, -v17, v49, v50
  v_fma_f32 v51, v17, v48, v51
  v_fma_f32 v48, v16, v50, v78
  v_fma_f32 v49, v16, v51, v94
  v_fma_f32 v48, -v17, v51, v48
  v_fma_f32 v49, v17, v50, v49
  v_fma_f32 v56, v16, v48, v79
  v_fma_f32 v57, v16, v49, v95
  v_fma_f32 v56, -v17, v49, v56
  v_fma_f32 v57, v17, v48, v57
  ds_write_b64 v4, v[56:57]
  v_mov_b32 v48, 151552
  v_mov_b32 v49, 1
  s_mov_b64 exec, 1
  ds_add_u32 v48, v49
  s_mov_b64 exec, -1
  s_mov_b32 s13, 0
L_S_sync:
  ds_read_b32 v49, v48
  s_add_u32 s13, s13, 1
  s_waitcnt lgkmcnt(0)
  v_readfirstlane_b32 s6, v49
  s_cmp_lt_u32 s13, 0x100000
  s_cselect_b32 s6, s6, 4
  s_cmp_lt_u32 s6, 4
  s_cbranch_scc1 L_S_sync
  ds_read_b64 v[36:37], v4 offset:1792
  ds_read_b64 v[34:35], v4 offset:1536
  ds_read_b64 v[32:33], v4 offset:1280
  ds_read_b64 v[30:31], v4 offset:1024
  ds_read_b64 v[28:29], v4 offset:768
  ds_read_b64 v[26:27], v4 offset:512
  ds_read_b64 v[24:25], v4 offset:256
  s_waitcnt lgkmcnt(5)
  v_fma_f32 v50, v18, v36, v34
  v_fma_f32 v51, v18, v37, v35
  v_fma_f32 v50, -v19, v37, v50
  v_fma_f32 v51, v19, v36, v51
  s_waitcnt lgkmcnt(4)
  v_fma_f32 v48, v18, v50, v32
  v_fma_f32 v49, v18, v51, v33
  v_fma_f32 v48, -v19, v51, v48
  v_fma_f32 v49, v19, v50, v49
  s_waitcnt lgkmcnt(3)
  v_fma_f32 v50, v18, v48, v30
  v_fma_f32 v51, v18, v49, v31
  v_fma_f32 v50, -v19, v49, v50
  v_fma_f32 v51, v19, v48, v51
  s_waitcnt lgkmcnt(2)
  v_fma_f32 v48, v18, v50, v28
  v_fma_f32 v49, v18, v51, v29
  v_fma_f32 v48, -v19, v51, v48
  v_fma_f32 v49, v19, v50, v49
  s_waitcnt lgkmcnt(1)
  v_fma_f32 v50, v18, v48, v26
  v_fma_f32 v51, v18, v49, v27
  v_fma_f32 v50, -v19, v49, v50
  v_fma_f32 v51, v19, v48, v51
  s_waitcnt lgkmcnt(0)
  v_fma_f32 v58, v18, v50, v24
  v_fma_f32 v59, v18, v51, v25
  v_fma_f32 v58, -v19, v51, v58
  v_fma_f32 v59, v19, v50, v59
  s_cmp_lg_u32 s7, 3
  s_cbranch_scc1 L_S_nopub
  v_fma_f32 v24, v18, v58, v56
  v_fma_f32 v26, v18, v59, v57
  v_fma_f32 v24, -v19, v59, v24
  v_fma_f32 v26, v19, v58, v26
  v_mov_b32 v25, s14
  v_mov_b32 v27, s14
  s_sub_u32 s6, 15, s4
  s_lshl_b32 s6, s6, 9
  v_lshlrev_b32 v28, 4, v8
  s_mov_b32 exec_lo, 0
  buffer_store_dwordx4 v[24:27], v28, s[68:71], s6 offen sc1
  s_mov_b64 exec, -1
L_S_nopub:
  v_lshrrev_b32 v48, 2, v1
  s_lshl_b32 s6, s7, 4
  v_add_u32 v48, s6, v48
  v_mul_u32_u24 v4, 2752, v48
  s_lshr_b32 s11, s5, 2
  s_mul_i32 s6, s5, 3
  s_sub_u32 s6, s6, s11
  s_lshl_b32 s6, s6, 6
  v_add_u32 v4, s6, v4
  v_and_b32 v48, 3, v1
  v_lshl_add_u32 v4, v48, 4, v4
  v_xor_b32 v7, 32, v4
  v_mul_f32 v48, v3, v64
  v_mul_f32 v64, v2, v64
  v_fma_f32 v64, -v3, v80, v64
  v_fma_f32 v80, v2, v80, v48
  v_mul_f32 v49, v3, v65
  v_mul_f32 v65, v2, v65
  v_fma_f32 v65, -v3, v81, v65
  v_fma_f32 v81, v2, v81, v49
  v_mul_f32 v50, v3, v66
  v_mul_f32 v66, v2, v66
  v_fma_f32 v66, -v3, v82, v66
  v_fma_f32 v82, v2, v82, v50
  v_mul_f32 v51, v3, v67
  v_mul_f32 v67, v2, v67
  v_fma_f32 v67, -v3, v83, v67
  v_fma_f32 v83, v2, v83, v51
  v_mul_f32 v48, v3, v68
  v_mul_f32 v68, v2, v68
  v_fma_f32 v68, -v3, v84, v68
  v_fma_f32 v84, v2, v84, v48
  v_mul_f32 v49, v3, v69
  v_mul_f32 v69, v2, v69
  v_fma_f32 v69, -v3, v85, v69
  v_fma_f32 v85, v2, v85, v49
  v_mul_f32 v50, v3, v70
  v_mul_f32 v70, v2, v70
  v_fma_f32 v70, -v3, v86, v70
  v_fma_f32 v86, v2, v86, v50
  v_mul_f32 v51, v3, v71
  v_mul_f32 v71, v2, v71
  v_fma_f32 v71, -v3, v87, v71
  v_fma_f32 v87, v2, v87, v51
  v_mul_f32 v48, v3, v72
  v_mul_f32 v72, v2, v72
  v_fma_f32 v72, -v3, v88, v72
  v_fma_f32 v88, v2, v88, v48
  v_mul_f32 v49, v3, v73
  v_mul_f32 v73, v2, v73
  v_fma_f32 v73, -v3, v89, v73
  v_fma_f32 v89, v2, v89, v49
  v_mul_f32 v50, v3, v74
  v_mul_f32 v74, v2, v74
  v_fma_f32 v74, -v3, v90, v74
  v_fma_f32 v90, v2, v90, v50
  v_mul_f32 v51, v3, v75
  v_mul_f32 v75, v2, v75
  v_fma_f32 v75, -v3, v91, v75
  v_fma_f32 v91, v2, v91, v51
  v_mul_f32 v48, v3, v76
  v_mul_f32 v76, v2, v76
  v_fma_f32 v76, -v3, v92, v76
  v_fma_f32 v92, v2, v92, v48
  v_mul_f32 v49, v3, v77
  v_mul_f32 v77, v2, v77
  v_fma_f32 v77, -v3, v93, v77
  v_fma_f32 v93, v2, v93, v49
  v_mul_f32 v50, v3, v78
  v_mul_f32 v78, v2, v78
  v_fma_f32 v78, -v3, v94, v78
  v_fma_f32 v94, v2, v94, v50
  v_mul_f32 v51, v3, v79
  v_mul_f32 v79, v2, v79
  v_fma_f32 v79, -v3, v95, v79
  v_fma_f32 v95, v2, v95, v51
  s_barrier
  v_add_u32 v14, 49152, v12
  v_add_u32 v15, 49152, v13
  ds_read_b64_tr_b16 v[32:33], v14 offset:0
  ds_read_b64_tr_b16 v[34:35], v14 offset:256
  ds_read_b64_tr_b16 v[36:37], v15 offset:0
  ds_read_b64_tr_b16 v[38:39], v15 offset:256
  ds_read_b64_tr_b16 v[40:41], v14 offset:6144
  ds_read_b64_tr_b16 v[42:43], v14 offset:6400
  ds_read_b64_tr_b16 v[44:45], v15 offset:6144
  ds_read_b64_tr_b16 v[46:47], v15 offset:6400
  s_waitcnt lgkmcnt(6)
  v_mfma_f32_32x32x16_bf16 v[96:111], v[32:35], a[0:3], 0
  s_add_u32 s11, s83, 2
  s_and_b32 s11, s11, 7
  s_mul_i32 s11, s11, 176128
  s_add_u32 m0, s10, 98304
  s_nop 0
  buffer_load_dwordx4 v4, s[56:59], s11 offen offset:0 lds
  s_waitcnt lgkmcnt(4)
  v_mfma_f32_32x32x16_bf16 v[112:127], v[36:39], a[0:3], 0
  ds_read_b64_tr_b16 v[32:33], v14 offset:12288
  ds_read_b64_tr_b16 v[34:35], v14 offset:12544
  s_waitcnt lgkmcnt(4)
  v_mfma_f32_32x32x16_bf16 v[96:111], v[40:43], a[4:7], v[96:111]
  s_add_u32 m0, s10, 99264
  s_add_u32 s12, s11, s92
  buffer_load_dwordx4 v4, s[56:59], s12 offen offset:64 lds
  ds_read_b64_tr_b16 v[36:37], v15 offset:12288
  ds_read_b64_tr_b16 v[38:39], v15 offset:12544
  s_waitcnt lgkmcnt(4)
  v_mfma_f32_32x32x16_bf16 v[112:127], v[44:47], a[4:7], v[112:127]
  ds_read_b64_tr_b16 v[40:41], v14 offset:18432
  ds_read_b64_tr_b16 v[42:43], v14 offset:18688
  s_waitcnt lgkmcnt(4)
  v_mfma_f32_32x32x16_bf16 v[96:111], v[32:35], a[8:11], v[96:111]
  s_add_u32 m0, s10, 100224
  s_add_u32 s12, s11, s93
  buffer_load_dwordx4 v4, s[56:59], s12 offen offset:128 lds
  ds_read_b64_tr_b16 v[44:45], v15 offset:18432
  ds_read_b64_tr_b16 v[46:47], v15 offset:18688
  s_waitcnt lgkmcnt(4)
  v_mfma_f32_32x32x16_bf16 v[112:127], v[36:39], a[8:11], v[112:127]
  s_barrier
  buffer_load_dwordx4 v[24:27], v60, s[68:71], 0 offen offset:0 sc1
  buffer_load_dwordx4 v[28:31], v60, s[68:71], 0 offen offset:1024 sc1
  v_add_u32 v14, 73728, v12
  v_add_u32 v15, 73728, v13
  ds_read_b64_tr_b16 v[32:33], v14 offset:0
  ds_read_b64_tr_b16 v[34:35], v14 offset:256
  s_waitcnt lgkmcnt(4)
  v_mfma_f32_32x32x16_bf16 v[96:111], v[40:43], a[12:15], v[96:111]
  s_add_u32 s11, s83, 3
  s_and_b32 s11, s11, 7
  s_mul_i32 s11, s11, 176128
  s_add_u32 m0, s10, 0
  s_nop 0
  buffer_load_dwordx4 v4, s[56:59], s11 offen offset:0 lds
  ds_read_b64_tr_b16 v[36:37], v15 offset:0
  ds_read_b64_tr_b16 v[38:39], v15 offset:256
  s_waitcnt lgkmcnt(4)
  v_mfma_f32_32x32x16_bf16 v[112:127], v[44:47], a[12:15], v[112:127]
  ds_read_b64_tr_b16 v[40:41], v14 offset:6144
  ds_read_b64_tr_b16 v[42:43], v14 offset:6400
  s_waitcnt lgkmcnt(4)
  v_mfma_f32_32x32x16_bf16 v[96:111], v[32:35], a[16:19], v[96:111]
  s_add_u32 m0, s10, 960
  s_add_u32 s12, s11, s92
  buffer_load_dwordx4 v4, s[56:59], s12 offen offset:64 lds
  ds_read_b64_tr_b16 v[44:45], v15 offset:6144
  ds_read_b64_tr_b16 v[46:47], v15 offset:6400
  s_waitcnt lgkmcnt(4)
  v_mfma_f32_32x32x16_bf16 v[112:127], v[36:39], a[16:19], v[112:127]
  ds_read_b64_tr_b16 v[32:33], v14 offset:12288
  ds_read_b64_tr_b16 v[34:35], v14 offset:12544
  s_waitcnt lgkmcnt(4)
  v_mfma_f32_32x32x16_bf16 v[96:111], v[40:43], a[20:23], v[96:111]
  s_add_u32 m0, s10, 1920
  s_add_u32 s12, s11, s93
  buffer_load_dwordx4 v4, s[56:59], s12 offen offset:128 lds
  ds_read_b64_tr_b16 v[36:37], v15 offset:12288
  ds_read_b64_tr_b16 v[38:39], v15 offset:12544
  s_waitcnt lgkmcnt(4)
  v_mfma_f32_32x32x16_bf16 v[112:127], v[44:47], a[20:23], v[112:127]
  ds_read_b64_tr_b16 v[40:41], v14 offset:18432
  ds_read_b64_tr_b16 v[42:43], v14 offset:18688
  s_waitcnt lgkmcnt(4)
  v_mfma_f32_32x32x16_bf16 v[96:111], v[32:35], a[24:27], v[96:111]
  s_add_u32 s11, s83, 4
  s_and_b32 s11, s11, 7
  s_mul_i32 s11, s11, 176128
  s_add_u32 m0, s10, 122880
  s_nop 0
  buffer_load_dwordx4 v4, s[56:59], s11 offen offset:0 lds
  ds_read_b64_tr_b16 v[44:45], v15 offset:18432
  ds_read_b64_tr_b16 v[46:47], v15 offset:18688
  s_waitcnt lgkmcnt(4)
  v_mfma_f32_32x32x16_bf16 v[112:127], v[36:39], a[24:27], v[112:127]
  s_waitcnt vmcnt(6)
  s_barrier
  v_add_u32 v14, 98304, v12
  v_add_u32 v15, 98304, v13
  ds_read_b64_tr_b16 v[32:33], v14 offset:0
  ds_read_b64_tr_b16 v[34:35], v14 offset:256
  s_mov_b32 s13, 0
  s_waitcnt vmcnt(4)
L_S_poll:
  v_mov_b32 v48, 0
  v_cmp_eq_u32 s[18:19], s14, v25
  v_cmp_eq_u32 s[20:21], s14, v27
  v_cmp_eq_u32 s[22:23], s14, v29
  v_cmp_eq_u32 s[24:25], s14, v31
  v_addc_co_u32 v48, vcc, 0, v48, s[18:19]
  v_addc_co_u32 v48, vcc, 0, v48, s[20:21]
  v_addc_co_u32 v48, vcc, 0, v48, s[22:23]
  v_addc_co_u32 v48, vcc, 0, v48, s[24:25]
  v_cmp_ne_u32 vcc, v62, v48
  s_cbranch_vccz L_S_ready
  s_sleep 2
  buffer_load_dwordx4 v[24:27], v60, s[68:71], 0 offen offset:0 sc1
  buffer_load_dwordx4 v[28:31], v60, s[68:71], 0 offen offset:1024 sc1
  s_add_u32 s13, s13, 1
  s_cmp_lt_u32 s13, 0x20000
  s_waitcnt vmcnt(0)
  s_cbranch_scc1 L_S_poll
L_S_ready:
  v_fma_f32 v48, v22, v28, v24
  v_fma_f32 v49, v22, v30, v26
  v_fma_f32 v48, -v23, v30, v48
  v_fma_f32 v49, v23, v28, v49
  v_mul_f32 v50, v20, v48
  v_mul_f32 v51, v20, v49
  v_fma_f32 v50, -v21, v49, v50
  v_fmac_f32 v51, v21, v48
  ds_write_b64 v61, v[50:51]
  s_waitcnt lgkmcnt(5)
  v_mfma_f32_32x32x16_bf16 v[96:111], v[40:43], a[28:31], v[96:111]
  s_add_u32 m0, s10, 123840
  s_add_u32 s12, s11, s92
  buffer_load_dwordx4 v4, s[56:59], s12 offen offset:64 lds
  ds_read_b64_tr_b16 v[36:37], v15 offset:0
  ds_read_b64_tr_b16 v[38:39], v15 offset:256
  s_waitcnt lgkmcnt(5)
  v_mfma_f32_32x32x16_bf16 v[112:127], v[44:47], a[28:31], v[112:127]
  ds_read_b64_tr_b16 v[40:41], v14 offset:6144
  ds_read_b64_tr_b16 v[42:43], v14 offset:6400
  s_waitcnt lgkmcnt(5)
  v_mfma_f32_32x32x16_bf16 v[96:111], v[32:35], a[32:35], v[96:111]
  s_add_u32 m0, s10, 124800
  s_add_u32 s12, s11, s93
  buffer_load_dwordx4 v4, s[56:59], s12 offen offset:128 lds
  ds_read_b64_tr_b16 v[44:45], v15 offset:6144
  ds_read_b64_tr_b16 v[46:47], v15 offset:6400
  s_waitcnt lgkmcnt(4)
  v_mfma_f32_32x32x16_bf16 v[112:127], v[36:39], a[32:35], v[112:127]
  ds_read_b64_tr_b16 v[32:33], v14 offset:12288
  ds_read_b64_tr_b16 v[34:35], v14 offset:12544
  s_waitcnt lgkmcnt(4)
  v_mfma_f32_32x32x16_bf16 v[96:111], v[40:43], a[36:39], v[96:111]
  s_add_u32 s11, s83, 5
  s_and_b32 s11, s11, 7
  s_mul_i32 s11, s11, 176128
  s_add_u32 m0, s10, 24576
  s_nop 0
  buffer_load_dwordx4 v4, s[56:59], s11 offen offset:0 lds
  ds_read_b64_tr_b16 v[36:37], v15 offset:12288
  ds_read_b64_tr_b16 v[38:39], v15 offset:12544
  s_waitcnt lgkmcnt(4)
  v_mfma_f32_32x32x16_bf16 v[112:127], v[44:47], a[36:39], v[112:127]
  ds_read_b64_tr_b16 v[40:41], v14 offset:18432
  ds_read_b64_tr_b16 v[42:43], v14 offset:18688
  s_waitcnt lgkmcnt(4)
  v_mfma_f32_32x32x16_bf16 v[96:111], v[32:35], a[40:43], v[96:111]
  s_add_u32 m0, s10, 25536
  s_add_u32 s12, s11, s92
  buffer_load_dwordx4 v4, s[56:59], s12 offen offset:64 lds
  ds_read_b64_tr_b16 v[44:45], v15 offset:18432
  ds_read_b64_tr_b16 v[46:47], v15 offset:18688
  s_waitcnt lgkmcnt(4)
  v_mfma_f32_32x32x16_bf16 v[112:127], v[36:39], a[40:43], v[112:127]
  s_waitcnt vmcnt(5)
  s_barrier
  v_add_u32 v14, 0, v12
  v_add_u32 v15, 0, v13
  ds_read_b64_tr_b16 v[32:33], v14 offset:0
  ds_read_b64_tr_b16 v[34:35], v14 offset:256
  ds_read_b64 v[24:25], v63 offset:0
  ds_read_b64 v[26:27], v63 offset:256
  ds_read_b64 v[28:29], v63 offset:512
  ds_read_b64 v[30:31], v63 offset:768
  ds_read_b64 v[48:49], v63 offset:1024
  ds_read_b64 v[50:51], v63 offset:1280
  ds_read_b64 v[52:53], v63 offset:1536
  ds_read_b64 v[56:57], v63 offset:1792
  s_lshl_b32 s6, s7, 4
  s_add_u32 s6, s6, s4
  s_cmp_lg_u32 s6, 15
  s_cbranch_scc1 L_S_noep
  v_mov_b32 v60, s14
  v_mov_b32 v61, 0
  s_mov_b64 exec, 1
  buffer_store_dword v60, v61, s[72:75], 0 offen offset:0 sc1
  s_mov_b64 exec, -1
L_S_noep:
  s_waitcnt lgkmcnt(0)
  v_add_f32 v24, v24, v26
  v_add_f32 v25, v25, v27
  v_add_f32 v28, v28, v30
  v_add_f32 v29, v29, v31
  v_add_f32 v48, v48, v50
  v_add_f32 v49, v49, v51
  v_add_f32 v52, v52, v56
  v_add_f32 v53, v53, v57
  v_add_f32 v24, v24, v28
  v_add_f32 v25, v25, v29
  v_add_f32 v48, v48, v52
  v_mfma_f32_32x32x16_bf16 v[96:111], v[40:43], a[44:47], v[96:111]
  s_add_u32 m0, s10, 26496
  s_add_u32 s12, s11, s93
  buffer_load_dwordx4 v4, s[56:59], s12 offen offset:128 lds
  ds_read_b64_tr_b16 v[36:37], v15 offset:0
  ds_read_b64_tr_b16 v[38:39], v15 offset:256
  v_add_f32 v49, v49, v53
  v_add_f32 v48, v48, v24
  v_add_f32 v49, v49, v25
  v_fma_f32 v50, v10, v48, v58
  v_fma_f32 v51, v10, v49, v59
  v_fma_f32 v50, -v11, v49, v50
  v_fma_f32 v51, v11, v48, v51
  v_mul_f32 v48, v2, v50
  v_mul_f32 v49, v2, v51
  v_fma_f32 v48, -v3, v51, v48
  v_fmac_f32 v49, v3, v50
  v_fmac_f32 v64, v16, v48
  v_fmac_f32 v80, v16, v49
  v_fmac_f32 v64, v5, v49
  v_mfma_f32_32x32x16_bf16 v[112:127], v[44:47], a[44:47], v[112:127]
  ds_read_b64_tr_b16 v[40:41], v14 offset:6144
  ds_read_b64_tr_b16 v[42:43], v14 offset:6400
  v_fmac_f32 v80, v17, v48
  v_fmac_f32 v65, v16, v64
  v_fmac_f32 v81, v16, v80
  v_fmac_f32 v65, v5, v80
  v_fmac_f32 v81, v17, v64
  v_fmac_f32 v66, v16, v65
  v_fmac_f32 v82, v16, v81
  v_fmac_f32 v66, v5, v81
  v_fmac_f32 v82, v17, v65
  v_fmac_f32 v67, v16, v66
  v_fmac_f32 v83, v16, v82
  v_fmac_f32 v67, v5, v82
  v_fmac_f32 v83, v17, v66
  v_fmac_f32 v68, v16, v67
  v_mfma_f32_32x32x16_bf16 v[96:111], v[32:35], a[48:51], v[96:111]
  s_add_u32 s11, s83, 6
  s_and_b32 s11, s11, 7
  s_mul_i32 s11, s11, 176128
  s_add_u32 m0, s10, 49152
  s_nop 0
  buffer_load_dwordx4 v4, s[56:59], s11 offen offset:0 lds
  ds_read_b64_tr_b16 v[44:45], v15 offset:6144
  ds_read_b64_tr_b16 v[46:47], v15 offset:6400
  v_fmac_f32 v84, v16, v83
  v_fmac_f32 v68, v5, v83
  v_fmac_f32 v84, v17, v67
  v_fmac_f32 v69, v16, v68
  v_fmac_f32 v85, v16, v84
  v_fmac_f32 v69, v5, v84
  v_fmac_f32 v85, v17, v68
  v_fmac_f32 v70, v16, v69
  v_fmac_f32 v86, v16, v85
  v_fmac_f32 v70, v5, v85
  v_fmac_f32 v86, v17, v69
  v_fmac_f32 v71, v16, v70
  v_fmac_f32 v87, v16, v86
  v_fmac_f32 v71, v5, v86
  s_waitcnt lgkmcnt(4)
  v_mfma_f32_32x32x16_bf16 v[112:127], v[36:39], a[48:51], v[112:127]
  ds_read_b64_tr_b16 v[32:33], v14 offset:12288
  ds_read_b64_tr_b16 v[34:35], v14 offset:12544
  v_fmac_f32 v87, v17, v70
  v_fmac_f32 v72, v16, v71
  v_fmac_f32 v88, v16, v87
  v_fmac_f32 v72, v5, v87
  v_fmac_f32 v88, v17, v71
  v_fmac_f32 v73, v16, v72
  v_fmac_f32 v89, v16, v88
  v_fmac_f32 v73, v5, v88
  v_fmac_f32 v89, v17, v72
  v_fmac_f32 v74, v16, v73
  v_fmac_f32 v90, v16, v89
  v_fmac_f32 v74, v5, v89
  v_fmac_f32 v90, v17, v73
  v_fmac_f32 v75, v16, v74
  s_waitcnt lgkmcnt(4)
  v_mfma_f32_32x32x16_bf16 v[96:111], v[40:43], a[52:55], v[96:111]
  s_add_u32 m0, s10, 50112
  s_add_u32 s12, s11, s92
  buffer_load_dwordx4 v4, s[56:59], s12 offen offset:64 lds
  ds_read_b64_tr_b16 v[36:37], v15 offset:12288
  ds_read_b64_tr_b16 v[38:39], v15 offset:12544
  v_fmac_f32 v91, v16, v90
  v_fmac_f32 v75, v5, v90
  v_fmac_f32 v91, v17, v74
  v_fmac_f32 v76, v16, v75
  v_fmac_f32 v92, v16, v91
  v_fmac_f32 v76, v5, v91
  v_fmac_f32 v92, v17, v75
  v_fmac_f32 v77, v16, v76
  v_fmac_f32 v93, v16, v92
  v_fmac_f32 v77, v5, v92
  v_fmac_f32 v93, v17, v76
  v_fmac_f32 v78, v16, v77
  v_fmac_f32 v94, v16, v93
  v_fmac_f32 v78, v5, v93
  s_waitcnt lgkmcnt(4)
  v_mfma_f32_32x32x16_bf16 v[112:127], v[44:47], a[52:55], v[112:127]
  ds_read_b64_tr_b16 v[40:41], v14 offset:18432
  ds_read_b64_tr_b16 v[42:43], v14 offset:18688
  v_fmac_f32 v94, v17, v77
  v_fmac_f32 v79, v16, v78
  v_fmac_f32 v95, v16, v94
  v_fmac_f32 v79, v5, v94
  v_fmac_f32 v95, v17, v78
  v_cvt_pk_bf16_f32 v64, v64, v65
  v_cvt_pk_bf16_f32 v65, v66, v67
  v_cvt_pk_bf16_f32 v66, v68, v69
  v_cvt_pk_bf16_f32 v67, v70, v71
  v_cvt_pk_bf16_f32 v68, v72, v73
  v_cvt_pk_bf16_f32 v69, v74, v75
  v_cvt_pk_bf16_f32 v70, v76, v77
  v_cvt_pk_bf16_f32 v71, v78, v79
  v_cvt_pk_bf16_f32 v80, -v80, -v81
  s_waitcnt lgkmcnt(4)
  v_mfma_f32_32x32x16_bf16 v[96:111], v[32:35], a[56:59], v[96:111]
  s_add_u32 m0, s10, 51072
  s_add_u32 s12, s11, s93
  buffer_load_dwordx4 v4, s[56:59], s12 offen offset:128 lds
  ds_read_b64_tr_b16 v[44:45], v15 offset:18432
  ds_read_b64_tr_b16 v[46:47], v15 offset:18688
  v_cvt_pk_bf16_f32 v81, -v82, -v83
  v_cvt_pk_bf16_f32 v82, -v84, -v85
  v_cvt_pk_bf16_f32 v83, -v86, -v87
  v_cvt_pk_bf16_f32 v84, -v88, -v89
  v_cvt_pk_bf16_f32 v85, -v90, -v91
  v_cvt_pk_bf16_f32 v86, -v92, -v93
  v_cvt_pk_bf16_f32 v87, -v94, -v95
  buffer_store_dwordx4 v[64:67], v54, s[64:67], s100 offen offset:0 sc0 sc1
  s_waitcnt lgkmcnt(4)
  v_mfma_f32_32x32x16_bf16 v[112:127], v[36:39], a[56:59], v[112:127]
  s_waitcnt vmcnt(7)
  s_barrier
  v_add_u32 v14, 122880, v12
  v_add_u32 v15, 122880, v13
  ds_read_b64_tr_b16 v[32:33], v14 offset:0
  ds_read_b64_tr_b16 v[34:35], v14 offset:256
  buffer_store_dwordx4 v[68:71], v55, s[64:67], s100 offen offset:1024 sc0 sc1
  s_waitcnt lgkmcnt(4)
  v_mfma_f32_32x32x16_bf16 v[96:111], v[40:43], a[60:63], v[96:111]
  s_add_u32 s11, s83, 7
  s_and_b32 s11, s11, 7
  s_mul_i32 s11, s11, 176128
  s_add_u32 m0, s10, 73728
  s_nop 0
  buffer_load_dwordx4 v4, s[56:59], s11 offen offset:0 lds
  ds_read_b64_tr_b16 v[36:37], v15 offset:0
  ds_read_b64_tr_b16 v[38:39], v15 offset:256
  buffer_store_dwordx4 v[80:83], v54, s[64:67], s101 offen offset:0 sc0 sc1
  s_waitcnt lgkmcnt(4)
  v_mfma_f32_32x32x16_bf16 v[112:127], v[44:47], a[60:63], v[112:127]
  ds_read_b64_tr_b16 v[40:41], v14 offset:6144
  ds_read_b64_tr_b16 v[42:43], v14 offset:6400
  buffer_store_dwordx4 v[84:87], v55, s[64:67], s101 offen offset:1024 sc0 sc1
  s_waitcnt lgkmcnt(4)
  v_mfma_f32_32x32x16_bf16 v[96:111], v[32:35], a[64:67], v[96:111]
  s_add_u32 m0, s10, 74688
  s_add_u32 s12, s11, s92
  buffer_load_dwordx4 v4, s[56:59], s12 offen offset:64 lds
  ds_read_b64_tr_b16 v[44:45], v15 offset:6144
  ds_read_b64_tr_b16 v[46:47], v15 offset:6400
  s_waitcnt lgkmcnt(4)
  v_mfma_f32_32x32x16_bf16 v[112:127], v[36:39], a[64:67], v[112:127]
  ds_read_b64_tr_b16 v[32:33], v14 offset:12288
  ds_read_b64_tr_b16 v[34:35], v14 offset:12544
  s_waitcnt lgkmcnt(4)
  v_mfma_f32_32x32x16_bf16 v[96:111], v[40:43], a[68:71], v[96:111]
  s_add_u32 m0, s10, 75648
  s_add_u32 s12, s11, s93
  buffer_load_dwordx4 v4, s[56:59], s12 offen offset:128 lds
  ds_read_b64_tr_b16 v[36:37], v15 offset:12288
  ds_read_b64_tr_b16 v[38:39], v15 offset:12544
  s_waitcnt lgkmcnt(4)
  v_mfma_f32_32x32x16_bf16 v[112:127], v[44:47], a[68:71], v[112:127]
  ds_read_b64_tr_b16 v[40:41], v14 offset:18432
  ds_read_b64_tr_b16 v[42:43], v14 offset:18688
  s_waitcnt lgkmcnt(4)
  v_mfma_f32_32x32x16_bf16 v[96:111], v[32:35], a[72:75], v[96:111]
  ds_read_b64_tr_b16 v[44:45], v15 offset:18432
  ds_read_b64_tr_b16 v[46:47], v15 offset:18688
  s_waitcnt lgkmcnt(4)
  v_mfma_f32_32x32x16_bf16 v[112:127], v[36:39], a[72:75], v[112:127]
  s_waitcnt vmcnt(10)
  s_barrier
  v_add_u32 v14, 24576, v12
  v_add_u32 v15, 24576, v13
  ds_read_b64_tr_b16 v[32:33], v14 offset:0
  ds_read_b64_tr_b16 v[34:35], v14 offset:256
  s_waitcnt lgkmcnt(4)
  v_mfma_f32_32x32x16_bf16 v[96:111], v[40:43], a[76:79], v[96:111]
  ds_read_b64_tr_b16 v[36:37], v15 offset:0
  ds_read_b64_tr_b16 v[38:39], v15 offset:256
  s_waitcnt lgkmcnt(4)
  v_mfma_f32_32x32x16_bf16 v[112:127], v[44:47], a[76:79], v[112:127]
  ds_read_b64_tr_b16 v[40:41], v14 offset:6144
  ds_read_b64_tr_b16 v[42:43], v14 offset:6400
  s_waitcnt lgkmcnt(4)
  v_mfma_f32_32x32x16_bf16 v[96:111], v[32:35], a[80:83], v[96:111]
  ds_read_b64_tr_b16 v[44:45], v15 offset:6144
  ds_read_b64_tr_b16 v[46:47], v15 offset:6400
  s_waitcnt lgkmcnt(4)
  v_mfma_f32_32x32x16_bf16 v[112:127], v[36:39], a[80:83], v[112:127]
  ds_read_b64_tr_b16 v[32:33], v14 offset:12288
  ds_read_b64_tr_b16 v[34:35], v14 offset:12544
  s_waitcnt lgkmcnt(4)
  v_mfma_f32_32x32x16_bf16 v[96:111], v[40:43], a[84:87], v[96:111]
  ds_read_b64_tr_b16 v[36:37], v15 offset:12288
  ds_read_b64_tr_b16 v[38:39], v15 offset:12544
  s_waitcnt lgkmcnt(4)
  v_mfma_f32_32x32x16_bf16 v[112:127], v[44:47], a[84:87], v[112:127]
  ds_read_b64_tr_b16 v[40:41], v14 offset:18432
  ds_read_b64_tr_b16 v[42:43], v14 offset:18688
  s_waitcnt lgkmcnt(4)
  v_mfma_f32_32x32x16_bf16 v[96:111], v[32:35], a[88:91], v[96:111]
  ds_read_b64_tr_b16 v[44:45], v15 offset:18432
  ds_read_b64_tr_b16 v[46:47], v15 offset:18688
  s_waitcnt lgkmcnt(4)
  v_mfma_f32_32x32x16_bf16 v[112:127], v[36:39], a[88:91], v[112:127]
  s_waitcnt vmcnt(0)
  s_waitcnt lgkmcnt(0)
  s_barrier
  v_add_u32 v14, 49152, v12
  v_add_u32 v15, 49152, v13
  ds_read_b64_tr_b16 v[32:33], v14 offset:0
  ds_read_b64_tr_b16 v[34:35], v14 offset:256
  v_mov_b32 v24, 151560
  v_mov_b32 v25, 1
  s_mov_b64 exec, 1
  ds_add_rtn_u32 v26, v24, v25
  s_mov_b64 exec, -1
  v_mfma_f32_32x32x16_bf16 v[96:111], v[40:43], a[92:95], v[96:111]
  ds_read_b64_tr_b16 v[36:37], v15 offset:0
  ds_read_b64_tr_b16 v[38:39], v15 offset:256
  s_waitcnt lgkmcnt(2)
  v_readfirstlane_b32 s6, v26
  s_cmp_lg_u32 s6, 3
  s_cbranch_scc1 L_S_nofl
  v_mov_b32 v24, s86
  v_mov_b32 v25, 0
  s_mov_b64 exec, 1
  buffer_store_dword v24, v25, s[88:91], s87 offen offset:0 sc1
  s_mov_b64 exec, -1
L_S_nofl:
  s_and_b32 s31, s4, 11
  s_lshr_b32 s11, s5, 3
  s_lshl_b32 s11, s11, 2
  s_add_u32 s31, s31, s11
  s_and_b32 s10, s4, 4
  s_and_b32 s11, s5, 3
  s_add_u32 s10, s10, s11
  s_bfe_u32 s11, s5, 0x10002
  s_and_b32 s6, s4, 3
  s_lshl_b32 s13, s6, 1
  s_add_u32 s13, s13, s10
  s_mul_i32 s14, s6, 3
  s_mul_i32 s6, s10, 11
  s_lshr_b32 s6, s6, 3
  s_add_u32 s14, s14, s6
  s_sub_u32 s6, s14, 11
  s_cmp_ge_u32 s14, 11
  s_cselect_b32 s14, s6, s14
  s_lshl_b32 s9, s7, 11
  s_cmp_lg_u32 s11, 0
  s_cselect_b64 s[48:49], s[28:29], s[26:27]
  v_and_b32 v11, 7, v1
  v_lshrrev_b32 v22, 3, v1
  v_lshrrev_b32 v10, 4, v1
  v_xor_b32 v10, v10, v11
  v_lshlrev_b32 v10, 4, v10
  v_lshl_add_u32 v4, v22, 10, v10
  s_lshl_b32 s6, s7, 14
  s_lshl_b32 s12, s10, 16
  s_add_u32 s12, s12, s6
  v_add_u32 v4, s12, v4
  v_xor_b32 v5, 64, v4
  v_add_u32 v5, 8192, v5
  v_mfma_f32_32x32x16_bf16 v[112:127], v[44:47], a[92:95], v[112:127]
  ds_read_b64_tr_b16 v[40:41], v14 offset:6144
  ds_read_b64_tr_b16 v[42:43], v14 offset:6400
  s_mov_b32 s68, s16
  s_mov_b32 s69, s17
  s_mov_b32 s70, 0x200000
  s_mov_b32 s71, 0x20000
  s_lshl_b32 s6, s31, 1
  s_add_u32 s6, s6, s11
  s_lshl_b32 s6, s6, 2
  s_add_u32 s6, s6, s7
  s_lshl_b32 s6, s6, 14
  s_lshl_b32 s12, s10, 7
  s_add_u32 s12, s12, s6
  v_and_b32 v10, 7, v1
  v_lshlrev_b32 v10, 4, v10
  v_lshl_add_u32 v10, v22, 10, v10
  s_add_u32 m0, s9, 98304
  s_add_u32 s6, s12, 8192
  buffer_load_dwordx4 v10, s[68:71], s12 offen lds
  s_add_u32 m0, s9, 99328
  s_nop 0
  buffer_load_dwordx4 v10, s[68:71], s6 offen lds
  s_mov_b32 s72, s40
  s_mov_b32 s73, s41
  s_mov_b32 s74, 0x400
  s_mov_b32 s75, 0x20000
  s_lshl_b32 s12, s10, 7
  s_mov_b32 m0, 156672
  s_mov_b64 exec, 0xff
  buffer_load_dwordx4 v6, s[72:75], s12 offen lds
  s_mov_b64 exec, -1
  v_mfma_f32_32x32x16_bf16 v[96:111], v[32:35], a[96:99], v[96:111]
  ds_read_b64_tr_b16 v[44:45], v15 offset:6144
  ds_read_b64_tr_b16 v[46:47], v15 offset:6400
  s_add_u32 s12, s13, 0
  s_and_b32 s12, s12, 7
  s_lshl_b32 s12, s12, 7
  s_add_u32 m0, s9, 0
  s_nop 0
  buffer_load_dwordx4 v4, s[48:51], s12 offen lds
  s_add_u32 m0, s9, 1024
  s_nop 0
  buffer_load_dwordx4 v5, s[48:51], s12 offen lds
  s_waitcnt lgkmcnt(4)
  v_mfma_f32_32x32x16_bf16 v[112:127], v[36:39], a[96:99], v[112:127]
  ds_read_b64_tr_b16 v[32:33], v14 offset:12288
  ds_read_b64_tr_b16 v[34:35], v14 offset:12544
  s_add_u32 s12, s13, 1
  s_and_b32 s12, s12, 7
  s_lshl_b32 s12, s12, 7
  s_add_u32 m0, s9, 8192
  s_nop 0
  buffer_load_dwordx4 v4, s[48:51], s12 offen lds
  s_add_u32 m0, s9, 9216
  s_nop 0
  buffer_load_dwordx4 v5, s[48:51], s12 offen lds
  s_waitcnt lgkmcnt(4)
  v_mfma_f32_32x32x16_bf16 v[96:111], v[40:43], a[100:103], v[96:111]
  ds_read_b64_tr_b16 v[36:37], v15 offset:12288
  ds_read_b64_tr_b16 v[38:39], v15 offset:12544
  s_add_u32 s12, s13, 2
  s_and_b32 s12, s12, 7
  s_lshl_b32 s12, s12, 7
  s_add_u32 m0, s9, 16384
  s_nop 0
  buffer_load_dwordx4 v4, s[48:51], s12 offen lds
  s_add_u32 m0, s9, 17408
  s_nop 0
  buffer_load_dwordx4 v5, s[48:51], s12 offen lds
  s_waitcnt lgkmcnt(4)
  v_mfma_f32_32x32x16_bf16 v[112:127], v[44:47], a[100:103], v[112:127]
  ds_read_b64_tr_b16 v[40:41], v14 offset:18432
  ds_read_b64_tr_b16 v[42:43], v14 offset:18688
  s_add_u32 s12, s13, 3
  s_and_b32 s12, s12, 7
  s_lshl_b32 s12, s12, 7
  s_add_u32 m0, s9, 24576
  s_nop 0
  buffer_load_dwordx4 v4, s[48:51], s12 offen lds
  s_add_u32 m0, s9, 25600
  s_nop 0
  buffer_load_dwordx4 v5, s[48:51], s12 offen lds
  s_waitcnt lgkmcnt(4)
  v_mfma_f32_32x32x16_bf16 v[96:111], v[32:35], a[104:107], v[96:111]
  ds_read_b64_tr_b16 v[44:45], v15 offset:18432
  ds_read_b64_tr_b16 v[46:47], v15 offset:18688
  s_add_u32 s12, s13, 4
  s_and_b32 s12, s12, 7
  s_lshl_b32 s12, s12, 7
  s_add_u32 m0, s9, 32768
  s_nop 0
  buffer_load_dwordx4 v4, s[48:51], s12 offen lds
  s_add_u32 m0, s9, 33792
  s_nop 0
  buffer_load_dwordx4 v5, s[48:51], s12 offen lds
  s_waitcnt lgkmcnt(4)
  v_mfma_f32_32x32x16_bf16 v[112:127], v[36:39], a[104:107], v[112:127]
  v_add_u32 v14, 73728, v12
  v_add_u32 v15, 73728, v13
  ds_read_b64_tr_b16 v[32:33], v14 offset:0
  ds_read_b64_tr_b16 v[34:35], v14 offset:256
  s_add_u32 s12, s13, 5
  s_and_b32 s12, s12, 7
  s_lshl_b32 s12, s12, 7
  s_add_u32 m0, s9, 40960
  s_nop 0
  buffer_load_dwordx4 v4, s[48:51], s12 offen lds
  s_add_u32 m0, s9, 41984
  s_nop 0
  buffer_load_dwordx4 v5, s[48:51], s12 offen lds
  s_waitcnt lgkmcnt(4)
  v_mfma_f32_32x32x16_bf16 v[96:111], v[40:43], a[108:111], v[96:111]
  ds_read_b64_tr_b16 v[36:37], v15 offset:0
  ds_read_b64_tr_b16 v[38:39], v15 offset:256
  s_and_b32 s12, s7, 1
  s_lshr_b32 s15, s7, 1
  s_lshl_b32 s15, s15, 11
  s_lshl_b32 s8, s12, 12
  s_add_u32 s8, s8, s15
  s_lshl_b32 s6, s11, 15
  s_add_u32 s6, s6, s15
  v_add_u32 v2, s6, v6
  s_mul_i32 s6, s11, 45056
  s_add_u32 s6, s6, s15
  s_add_u32 s6, s6, 65536
  v_add_u32 v23, s6, v6
  s_lshl_b32 s6, s31, 1
  s_add_u32 s6, s6, s11
  s_lshl_b32 s6, s6, 1
  s_add_u32 s6, s6, s12
  s_xor_b32 s15, s6, 2
  s_mul_i32 s6, s6, 153600
  s_mul_i32 s15, s15, 153600
  s_add_u32 s60, s42, s6
  s_addc_u32 s61, s43, 0
  s_mov_b32 s62, 0x25800
  s_mov_b32 s63, 0x20000
  s_add_u32 s56, s42, s15
  s_addc_u32 s57, s43, 0
  s_mov_b32 s58, 0x25800
  s_mov_b32 s59, 0x20000
  v_bfe_u32 v10, v1, 4, 1
  v_lshlrev_b32 v10, 2, v10
  v_xor_b32 v10, v10, v11
  v_lshlrev_b32 v10, 4, v10
  v_lshl_add_u32 v3, v22, 10, v10
  s_lshl_b32 s6, s7, 14
  s_lshl_b32 s12, s10, 7
  s_add_u32 s12, s12, s6
  s_mul_i32 s6, s11, 720896
  s_add_u32 s12, s12, s6
  v_add_u32 v3, s12, v3
  v_add_u32 v7, 8192, v3
  v_and_b32 v17, 15, v1
  s_and_b32 s6, s31, 7
  s_lshl_b32 s6, s6, 9
  v_lshl_add_u32 v17, v17, 2, s6
  s_waitcnt lgkmcnt(4)
  v_mfma_f32_32x32x16_bf16 v[112:127], v[44:47], a[108:111], v[112:127]
  ds_read_b64_tr_b16 v[40:41], v14 offset:6144
  ds_read_b64_tr_b16 v[42:43], v14 offset:6400
  s_waitcnt lgkmcnt(4)
  v_mfma_f32_32x32x16_bf16 v[96:111], v[32:35], a[112:115], v[96:111]
  ds_read_b64_tr_b16 v[44:45], v15 offset:6144
  ds_read_b64_tr_b16 v[46:47], v15 offset:6400
  s_waitcnt lgkmcnt(4)
  v_mfma_f32_32x32x16_bf16 v[112:127], v[36:39], a[112:115], v[112:127]
  ds_read_b64_tr_b16 v[32:33], v14 offset:12288
  ds_read_b64_tr_b16 v[34:35], v14 offset:12544
  s_waitcnt lgkmcnt(4)
  v_mfma_f32_32x32x16_bf16 v[96:111], v[40:43], a[116:119], v[96:111]
  ds_read_b64_tr_b16 v[36:37], v15 offset:12288
  ds_read_b64_tr_b16 v[38:39], v15 offset:12544
  s_waitcnt lgkmcnt(4)
  v_mfma_f32_32x32x16_bf16 v[112:127], v[44:47], a[116:119], v[112:127]
  ds_read_b64_tr_b16 v[40:41], v14 offset:18432
  ds_read_b64_tr_b16 v[42:43], v14 offset:18688
  s_waitcnt lgkmcnt(4)
  v_mfma_f32_32x32x16_bf16 v[96:111], v[32:35], a[120:123], v[96:111]
  ds_read_b64_tr_b16 v[44:45], v15 offset:18432
  ds_read_b64_tr_b16 v[46:47], v15 offset:18688
  s_waitcnt lgkmcnt(4)
  v_mfma_f32_32x32x16_bf16 v[112:127], v[36:39], a[120:123], v[112:127]
  s_waitcnt lgkmcnt(2)
  v_mfma_f32_32x32x16_bf16 v[96:111], v[40:43], a[124:127], v[96:111]
  s_waitcnt lgkmcnt(0)
  v_mfma_f32_32x32x16_bf16 v[112:127], v[44:47], a[124:127], v[112:127]
  buffer_load_dword v16, v17, s[88:91], 0 offen sc1
  s_nop 8
  s_nop 9
  v_mul_f32 v104, v96, v104
  v_mul_f32 v105, v97, v105
  v_mul_f32 v106, v98, v106
  v_mul_f32 v107, v99, v107
  v_mul_f32 v108, v100, v108
  v_mul_f32 v109, v101, v109
  v_mul_f32 v110, v102, v110
  v_mul_f32 v111, v103, v111
  v_mul_f32 v96, s80, v96
  v_mul_f32 v97, s80, v97
  v_mul_f32 v98, s80, v98
  v_mul_f32 v99, s80, v99
  v_mul_f32 v100, s80, v100
  v_mul_f32 v101, s80, v101
  v_mul_f32 v102, s80, v102
  v_mul_f32 v103, s80, v103
  v_exp_f32 v96, v96
  v_exp_f32 v97, v97
  v_exp_f32 v98, v98
  v_exp_f32 v99, v99
  v_exp_f32 v100, v100
  v_exp_f32 v101, v101
  v_exp_f32 v102, v102
  v_exp_f32 v103, v103
  v_add_f32 v96, 1.0, v96
  v_add_f32 v97, 1.0, v97
  v_add_f32 v98, 1.0, v98
  v_add_f32 v99, 1.0, v99
  v_add_f32 v100, 1.0, v100
  v_add_f32 v101, 1.0, v101
  v_add_f32 v102, 1.0, v102
  v_add_f32 v103, 1.0, v103
  v_rcp_f32 v96, v96
  v_rcp_f32 v97, v97
  v_rcp_f32 v98, v98
  v_rcp_f32 v99, v99
  v_rcp_f32 v100, v100
  v_rcp_f32 v101, v101
  v_rcp_f32 v102, v102
  v_rcp_f32 v103, v103
  v_mul_f32 v104, v104, v96
  v_mul_f32 v105, v105, v97
  v_mul_f32 v106, v106, v98
  v_mul_f32 v107, v107, v99
  v_mul_f32 v108, v108, v100
  v_mul_f32 v109, v109, v101
  v_mul_f32 v110, v110, v102
  v_mul_f32 v111, v111, v103
  v_cvt_pk_bf16_f32 v96, v104, v105
  v_cvt_pk_bf16_f32 v97, v106, v107
  v_cvt_pk_bf16_f32 v98, v108, v109
  v_cvt_pk_bf16_f32 v99, v110, v111
  buffer_store_dwordx4 v[96:99], v6, s[64:67], s82 offen offset:0 sc0 sc1
  s_mov_b32 s15, 0
  s_waitcnt vmcnt(1)
L_p2a_poll:
  v_cmp_ne_u32 vcc, s86, v16
  s_cbranch_vccz L_p2a_go
  s_sleep 8
  buffer_load_dword v16, v17, s[88:91], 0 offen offset:0 sc1
  s_add_u32 s15, s15, 1
  s_cmp_lt_u32 s15, 0x20000
  s_waitcnt vmcnt(0)
  s_cbranch_scc1 L_p2a_poll
L_p2a_go:
  s_add_u32 s12, s13, 0
  s_and_b32 s12, s12, 7
  s_lshl_b32 s12, s12, 12
  s_add_u32 m0, s8, 106496
  s_nop 0
  buffer_load_dwordx4 v2, s[56:59], s12 offen sc1 lds
  buffer_load_dwordx4 v2, s[56:59], s12 offen offset:1024 sc1 lds
  s_add_u32 s12, s13, 1
  s_and_b32 s12, s12, 7
  s_lshl_b32 s12, s12, 12
  s_add_u32 m0, s8, 114688
  s_nop 0
  buffer_load_dwordx4 v2, s[56:59], s12 offen sc1 lds
  buffer_load_dwordx4 v2, s[56:59], s12 offen offset:1024 sc1 lds
  s_add_u32 s72, s42, 0xa20000
  s_addc_u32 s73, s43, 0
  s_mov_b32 s74, 0x4000
  s_mov_b32 s75, 0x20000
  s_lshl_b32 s12, s31, 2
  s_add_u32 s12, s12, s7
  s_lshl_b32 s12, s12, 8
  s_lshl_b32 s6, s7, 8
  s_add_u32 m0, s6, 155648
  s_mov_b64 exec, 0xffff
  buffer_load_dwordx4 v6, s[72:75], s12 offen sc1 lds
  s_mov_b64 exec, -1
  v_mul_f32 v120, v112, v120
  v_mul_f32 v121, v113, v121
  v_mul_f32 v122, v114, v122
  v_mul_f32 v123, v115, v123
  v_mul_f32 v124, v116, v124
  v_mul_f32 v125, v117, v125
  v_mul_f32 v126, v118, v126
  v_mul_f32 v127, v119, v127
  v_mul_f32 v112, s80, v112
  v_mul_f32 v113, s80, v113
  v_mul_f32 v114, s80, v114
  v_mul_f32 v115, s80, v115
  v_mul_f32 v116, s80, v116
  v_mul_f32 v117, s80, v117
  v_mul_f32 v118, s80, v118
  v_mul_f32 v119, s80, v119
  v_exp_f32 v112, v112
  v_exp_f32 v113, v113
  v_exp_f32 v114, v114
  v_exp_f32 v115, v115
  v_exp_f32 v116, v116
  v_exp_f32 v117, v117
  v_exp_f32 v118, v118
  v_exp_f32 v119, v119
  v_add_f32 v112, 1.0, v112
  v_add_f32 v113, 1.0, v113
  v_add_f32 v114, 1.0, v114
  v_add_f32 v115, 1.0, v115
  v_add_f32 v116, 1.0, v116
  v_add_f32 v117, 1.0, v117
  v_add_f32 v118, 1.0, v118
  v_add_f32 v119, 1.0, v119
  v_rcp_f32 v112, v112
  v_rcp_f32 v113, v113
  v_rcp_f32 v114, v114
  v_rcp_f32 v115, v115
  v_rcp_f32 v116, v116
  v_rcp_f32 v117, v117
  v_rcp_f32 v118, v118
  v_rcp_f32 v119, v119
  v_mul_f32 v120, v120, v112
  v_mul_f32 v121, v121, v113
  v_mul_f32 v122, v122, v114
  v_mul_f32 v123, v123, v115
  v_mul_f32 v124, v124, v116
  v_mul_f32 v125, v125, v117
  v_mul_f32 v126, v126, v118
  v_mul_f32 v127, v127, v119
  v_cvt_pk_bf16_f32 v112, v120, v121
  v_cvt_pk_bf16_f32 v113, v122, v123
  v_cvt_pk_bf16_f32 v114, v124, v125
  v_cvt_pk_bf16_f32 v115, v126, v127
  s_add_u32 s12, s13, 2
  s_and_b32 s12, s12, 7
  s_lshl_b32 s12, s12, 12
  s_add_u32 m0, s8, 122880
  s_barrier
  buffer_load_dwordx4 v2, s[56:59], s12 offen sc1 lds
  buffer_load_dwordx4 v2, s[56:59], s12 offen offset:1024 sc1 lds
  s_add_u32 s12, s13, 2
  s_and_b32 s12, s12, 7
  s_lshl_b32 s12, s12, 12
  s_add_u32 m0, s8, 131072
  s_nop 0
  buffer_load_dwordx4 v2, s[60:63], s12 offen sc1 lds
  buffer_load_dwordx4 v2, s[60:63], s12 offen offset:1024 sc1 lds
  s_add_u32 s12, s13, 3
  s_and_b32 s12, s12, 7
  s_lshl_b32 s12, s12, 12
  s_add_u32 m0, s8, 139264
  s_waitcnt vmcnt(7)
  s_barrier
  buffer_load_dwordx4 v2, s[56:59], s12 offen sc1 lds
  buffer_load_dwordx4 v2, s[56:59], s12 offen offset:1024 sc1 lds
  s_add_u32 s12, s13, 3
  s_and_b32 s12, s12, 7
  s_lshl_b32 s12, s12, 12
  s_add_u32 m0, s8, 147456
  s_nop 0
  buffer_load_dwordx4 v2, s[60:63], s12 offen sc1 lds
  buffer_load_dwordx4 v2, s[60:63], s12 offen offset:1024 sc1 lds
  buffer_store_dwordx4 v[112:115], v6, s[64:67], s82 offen offset:1024 sc0 sc1
  s_add_u32 s12, s13, 4
  s_and_b32 s12, s12, 7
  s_lshl_b32 s12, s12, 12
  s_add_u32 m0, s8, 98304
  s_waitcnt vmcnt(10)
  s_barrier
  buffer_load_dwordx4 v2, s[56:59], s12 offen sc1 lds
  buffer_load_dwordx4 v2, s[56:59], s12 offen offset:1024 sc1 lds
  s_add_u32 s12, s13, 6
  s_and_b32 s12, s12, 7
  s_lshl_b32 s12, s12, 7
  s_add_u32 m0, s9, 49152
  s_nop 0
  buffer_load_dwordx4 v4, s[48:51], s12 offen lds
  s_add_u32 m0, s9, 50176
  s_nop 0
  buffer_load_dwordx4 v5, s[48:51], s12 offen lds
  s_add_u32 s12, s13, 4
  s_and_b32 s12, s12, 7
  s_lshl_b32 s12, s12, 12
  s_add_u32 m0, s8, 106496
  s_waitcnt vmcnt(11)
  s_barrier
  buffer_load_dwordx4 v2, s[60:63], s12 offen sc1 lds
  buffer_load_dwordx4 v2, s[60:63], s12 offen offset:1024 sc1 lds
  s_add_u32 s12, s13, 7
  s_and_b32 s12, s12, 7
  s_lshl_b32 s12, s12, 7
  s_add_u32 m0, s9, 57344
  s_nop 0
  buffer_load_dwordx4 v4, s[48:51], s12 offen lds
  s_add_u32 m0, s9, 58368
  s_nop 0
  buffer_load_dwordx4 v5, s[48:51], s12 offen lds
  s_add_u32 s12, s13, 5
  s_and_b32 s12, s12, 7
  s_lshl_b32 s12, s12, 12
  s_add_u32 m0, s8, 114688
  s_waitcnt vmcnt(13)
  s_barrier
  buffer_load_dwordx4 v2, s[56:59], s12 offen sc1 lds
  buffer_load_dwordx4 v2, s[56:59], s12 offen offset:1024 sc1 lds
  s_add_u32 s12, s14, 0
  s_sub_u32 s6, s12, 11
  s_cmp_ge_u32 s12, 11
  s_cselect_b32 s12, s6, s12
  s_lshl_b32 s12, s12, 16
  s_add_u32 m0, s9, 65536
  s_nop 0
  buffer_load_dwordx4 v3, s[44:47], s12 offen lds
  s_add_u32 m0, s9, 66560
  s_nop 0
  buffer_load_dwordx4 v7, s[44:47], s12 offen lds
  s_waitcnt vmcnt(15)
  s_waitcnt vmcnt(12)
  s_barrier
  s_cmp_lg_u32 s3, 0
  s_cbranch_scc1 L_p2_nofl
  v_mov_b32 v10, s86
  v_mov_b32 v11, 0
  s_mov_b64 exec, 1
  buffer_store_dword v10, v11, s[88:91], s87 offen offset:256 sc1
  s_mov_b64 exec, -1
L_p2_nofl:
  s_add_u32 s12, s13, 5
  s_and_b32 s12, s12, 7
  s_lshl_b32 s12, s12, 12
  s_add_u32 m0, s8, 122880
  s_nop 0
  buffer_load_dwordx4 v2, s[60:63], s12 offen sc1 lds
  buffer_load_dwordx4 v2, s[60:63], s12 offen offset:1024 sc1 lds
  s_add_u32 s12, s14, 1
  s_sub_u32 s6, s12, 11
  s_cmp_ge_u32 s12, 11
  s_cselect_b32 s12, s6, s12
  s_lshl_b32 s12, s12, 16
  s_add_u32 m0, s9, 73728
  s_nop 0
  buffer_load_dwordx4 v3, s[44:47], s12 offen lds
  s_add_u32 m0, s9, 74752
  s_nop 0
  buffer_load_dwordx4 v7, s[44:47], s12 offen lds
  s_add_u32 s12, s13, 6
  s_and_b32 s12, s12, 7
  s_lshl_b32 s12, s12, 12
  s_add_u32 m0, s8, 131072
  s_barrier
  buffer_load_dwordx4 v2, s[56:59], s12 offen sc1 lds
  buffer_load_dwordx4 v2, s[56:59], s12 offen offset:1024 sc1 lds
  s_add_u32 s12, s14, 2
  s_sub_u32 s6, s12, 11
  s_cmp_ge_u32 s12, 11
  s_cselect_b32 s12, s6, s12
  s_lshl_b32 s12, s12, 16
  s_add_u32 m0, s9, 81920
  s_nop 0
  buffer_load_dwordx4 v3, s[44:47], s12 offen lds
  s_add_u32 m0, s9, 82944
  s_nop 0
  buffer_load_dwordx4 v7, s[44:47], s12 offen lds
  s_add_u32 s12, s13, 6
  s_and_b32 s12, s12, 7
  s_lshl_b32 s12, s12, 12
  s_add_u32 m0, s8, 139264
  s_waitcnt vmcnt(18)
  s_barrier
  buffer_load_dwordx4 v2, s[60:63], s12 offen sc1 lds
  buffer_load_dwordx4 v2, s[60:63], s12 offen offset:1024 sc1 lds
  s_add_u32 s12, s14, 3
  s_sub_u32 s6, s12, 11
  s_cmp_ge_u32 s12, 11
  s_cselect_b32 s12, s6, s12
  s_lshl_b32 s12, s12, 16
  s_add_u32 m0, s9, 90112
  s_nop 0
  buffer_load_dwordx4 v3, s[44:47], s12 offen lds
  s_add_u32 m0, s9, 91136
  s_nop 0
  buffer_load_dwordx4 v7, s[44:47], s12 offen lds
  s_add_u32 s12, s13, 7
  s_and_b32 s12, s12, 7
  s_lshl_b32 s12, s12, 12
  s_add_u32 m0, s8, 147456
  s_waitcnt vmcnt(18)
  s_barrier
  buffer_load_dwordx4 v2, s[56:59], s12 offen sc1 lds
  buffer_load_dwordx4 v2, s[56:59], s12 offen offset:1024 sc1 lds
  s_add_u32 s12, s14, 4
  s_sub_u32 s6, s12, 11
  s_cmp_ge_u32 s12, 11
  s_cselect_b32 s12, s6, s12
  s_lshl_b32 s12, s12, 16
  s_add_u32 m0, s9, 0
  s_nop 0
  buffer_load_dwordx4 v3, s[44:47], s12 offen lds
  s_add_u32 m0, s9, 1024
  s_nop 0
  buffer_load_dwordx4 v7, s[44:47], s12 offen lds
  s_add_u32 s12, s13, 7
  s_and_b32 s12, s12, 7
  s_lshl_b32 s12, s12, 12
  s_add_u32 m0, s8, 98304
  s_waitcnt vmcnt(18)
  s_barrier
  buffer_load_dwordx4 v2, s[60:63], s12 offen sc1 lds
  buffer_load_dwordx4 v2, s[60:63], s12 offen offset:1024 sc1 lds
  s_add_u32 s12, s14, 5
  s_sub_u32 s6, s12, 11
  s_cmp_ge_u32 s12, 11
  s_cselect_b32 s12, s6, s12
  s_lshl_b32 s12, s12, 16
  s_add_u32 m0, s9, 8192
  s_nop 0
  buffer_load_dwordx4 v3, s[44:47], s12 offen lds
  s_add_u32 m0, s9, 9216
  s_nop 0
  buffer_load_dwordx4 v7, s[44:47], s12 offen lds
  s_waitcnt vmcnt(18)
  s_barrier
  buffer_load_dword v16, v17, s[88:91], 0 offen offset:256 sc1
  s_add_u32 s12, s14, 6
  s_sub_u32 s6, s12, 11
  s_cmp_ge_u32 s12, 11
  s_cselect_b32 s12, s6, s12
  s_lshl_b32 s12, s12, 16
  s_add_u32 m0, s9, 16384
  s_nop 0
  buffer_load_dwordx4 v3, s[44:47], s12 offen lds
  s_add_u32 m0, s9, 17408
  s_nop 0
  buffer_load_dwordx4 v7, s[44:47], s12 offen lds
  s_add_u32 s12, s14, 7
  s_sub_u32 s6, s12, 11
  s_cmp_ge_u32 s12, 11
  s_cselect_b32 s12, s6, s12
  s_lshl_b32 s12, s12, 16
  s_add_u32 m0, s9, 24576
  s_nop 0
  buffer_load_dwordx4 v3, s[44:47], s12 offen lds
  s_add_u32 m0, s9, 25600
  s_nop 0
  buffer_load_dwordx4 v7, s[44:47], s12 offen lds
  s_add_u32 s12, s14, 8
  s_sub_u32 s6, s12, 11
  s_cmp_ge_u32 s12, 11
  s_cselect_b32 s12, s6, s12
  s_lshl_b32 s12, s12, 16
  s_add_u32 m0, s9, 32768
  s_waitcnt vmcnt(19)
  s_barrier
  buffer_load_dwordx4 v3, s[44:47], s12 offen lds
  s_add_u32 m0, s9, 33792
  s_nop 0
  buffer_load_dwordx4 v7, s[44:47], s12 offen lds
  s_add_u32 s12, s14, 9
  s_sub_u32 s6, s12, 11
  s_cmp_ge_u32 s12, 11
  s_cselect_b32 s12, s6, s12
  s_lshl_b32 s12, s12, 16
  s_add_u32 m0, s9, 40960
  s_nop 0
  buffer_load_dwordx4 v3, s[44:47], s12 offen lds
  s_add_u32 m0, s9, 41984
  s_nop 0
  buffer_load_dwordx4 v7, s[44:47], s12 offen lds
  s_waitcnt vmcnt(19)
  s_barrier
  s_mov_b32 s15, 0
  s_waitcnt vmcnt(8)
L_p2b_poll:
  v_cmp_ne_u32 vcc, s86, v16
  s_cbranch_vccz L_p2b_go
  s_sleep 8
  buffer_load_dword v16, v17, s[88:91], 0 offen offset:256 sc1
  s_add_u32 s15, s15, 1
  s_cmp_lt_u32 s15, 0x20000
  s_waitcnt vmcnt(0)
  s_cbranch_scc1 L_p2b_poll
L_p2b_go:
  s_add_u32 s12, s14, 0
  s_sub_u32 s6, s12, 11
  s_cmp_ge_u32 s12, 11
  s_cselect_b32 s12, s6, s12
  s_lshl_b32 s12, s12, 12
  s_add_u32 m0, s8, 106496
  s_nop 0
  buffer_load_dwordx4 v23, s[56:59], s12 offen sc1 lds
  buffer_load_dwordx4 v23, s[56:59], s12 offen offset:1024 sc1 lds
  s_add_u32 s12, s14, 1
  s_sub_u32 s6, s12, 11
  s_cmp_ge_u32 s12, 11
  s_cselect_b32 s12, s6, s12
  s_lshl_b32 s12, s12, 12
  s_add_u32 m0, s8, 114688
  s_nop 0
  buffer_load_dwordx4 v23, s[56:59], s12 offen sc1 lds
  buffer_load_dwordx4 v23, s[56:59], s12 offen offset:1024 sc1 lds
  s_add_u32 s12, s14, 2
  s_sub_u32 s6, s12, 11
  s_cmp_ge_u32 s12, 11
  s_cselect_b32 s12, s6, s12
  s_lshl_b32 s12, s12, 12
  s_add_u32 m0, s8, 122880
  s_nop 0
  buffer_load_dwordx4 v23, s[56:59], s12 offen sc1 lds
  buffer_load_dwordx4 v23, s[56:59], s12 offen offset:1024 sc1 lds
  s_add_u32 s12, s14, 3
  s_sub_u32 s6, s12, 11
  s_cmp_ge_u32 s12, 11
  s_cselect_b32 s12, s6, s12
  s_lshl_b32 s12, s12, 12
  s_add_u32 m0, s8, 131072
  s_barrier
  buffer_load_dwordx4 v23, s[56:59], s12 offen sc1 lds
  buffer_load_dwordx4 v23, s[56:59], s12 offen offset:1024 sc1 lds
  s_add_u32 s12, s14, 10
  s_sub_u32 s6, s12, 11
  s_cmp_ge_u32 s12, 11
  s_cselect_b32 s12, s6, s12
  s_lshl_b32 s12, s12, 16
  s_add_u32 m0, s9, 49152
  s_nop 0
  buffer_load_dwordx4 v3, s[44:47], s12 offen lds
  s_add_u32 m0, s9, 50176
  s_nop 0
  buffer_load_dwordx4 v7, s[44:47], s12 offen lds
  s_add_u32 s12, s14, 4
  s_sub_u32 s6, s12, 11
  s_cmp_ge_u32 s12, 11
  s_cselect_b32 s12, s6, s12
  s_lshl_b32 s12, s12, 12
  s_add_u32 m0, s8, 139264
  s_barrier
  buffer_load_dwordx4 v23, s[56:59], s12 offen sc1 lds
  buffer_load_dwordx4 v23, s[56:59], s12 offen offset:1024 sc1 lds
  s_add_u32 s12, s14, 5
  s_sub_u32 s6, s12, 11
  s_cmp_ge_u32 s12, 11
  s_cselect_b32 s12, s6, s12
  s_lshl_b32 s12, s12, 12
  s_add_u32 m0, s8, 147456
  s_waitcnt vmcnt(10)
  s_barrier
  buffer_load_dwordx4 v23, s[56:59], s12 offen sc1 lds
  buffer_load_dwordx4 v23, s[56:59], s12 offen offset:1024 sc1 lds
  s_add_u32 s12, s14, 6
  s_sub_u32 s6, s12, 11
  s_cmp_ge_u32 s12, 11
  s_cselect_b32 s12, s6, s12
  s_lshl_b32 s12, s12, 12
  s_add_u32 m0, s8, 98304
  s_waitcnt vmcnt(10)
  s_barrier
  buffer_load_dwordx4 v23, s[56:59], s12 offen sc1 lds
  buffer_load_dwordx4 v23, s[56:59], s12 offen offset:1024 sc1 lds
  s_add_u32 s12, s14, 7
  s_sub_u32 s6, s12, 11
  s_cmp_ge_u32 s12, 11
  s_cselect_b32 s12, s6, s12
  s_lshl_b32 s12, s12, 12
  s_add_u32 m0, s8, 106496
  s_waitcnt vmcnt(10)
  s_barrier
  buffer_load_dwordx4 v23, s[56:59], s12 offen sc1 lds
  buffer_load_dwordx4 v23, s[56:59], s12 offen offset:1024 sc1 lds
  s_add_u32 s12, s14, 8
  s_sub_u32 s6, s12, 11
  s_cmp_ge_u32 s12, 11
  s_cselect_b32 s12, s6, s12
  s_lshl_b32 s12, s12, 12
  s_add_u32 m0, s8, 114688
  s_waitcnt vmcnt(10)
  s_barrier
  buffer_load_dwordx4 v23, s[56:59], s12 offen sc1 lds
  buffer_load_dwordx4 v23, s[56:59], s12 offen offset:1024 sc1 lds
  s_add_u32 s12, s14, 9
  s_sub_u32 s6, s12, 11
  s_cmp_ge_u32 s12, 11
  s_cselect_b32 s12, s6, s12
  s_lshl_b32 s12, s12, 12
  s_add_u32 m0, s8, 122880
  s_waitcnt vmcnt(8)
  s_barrier
  buffer_load_dwordx4 v23, s[56:59], s12 offen sc1 lds
  buffer_load_dwordx4 v23, s[56:59], s12 offen offset:1024 sc1 lds
  s_add_u32 s12, s14, 10
  s_sub_u32 s6, s12, 11
  s_cmp_ge_u32 s12, 11
  s_cselect_b32 s12, s6, s12
  s_lshl_b32 s12, s12, 12
  s_add_u32 m0, s8, 131072
  s_waitcnt vmcnt(8)
  s_barrier
  buffer_load_dwordx4 v23, s[56:59], s12 offen sc1 lds
  buffer_load_dwordx4 v23, s[56:59], s12 offen offset:1024 sc1 lds
  s_add_u32 s12, s13, 0
  s_and_b32 s12, s12, 7
  s_lshl_b32 s12, s12, 12
  s_add_u32 m0, s8, 139264
  s_waitcnt vmcnt(8)
  s_barrier
  buffer_load_dwordx4 v2, s[60:63], s12 offen sc1 lds
  buffer_load_dwordx4 v2, s[60:63], s12 offen offset:1024 sc1 lds
  s_add_u32 s12, s13, 1
  s_and_b32 s12, s12, 7
  s_lshl_b32 s12, s12, 12
  s_add_u32 m0, s8, 147456
  s_waitcnt vmcnt(8)
  s_barrier
  buffer_load_dwordx4 v2, s[60:63], s12 offen sc1 lds
  buffer_load_dwordx4 v2, s[60:63], s12 offen offset:1024 sc1 lds
  s_add_u32 s12, s14, 0
  s_sub_u32 s6, s12, 11
  s_cmp_ge_u32 s12, 11
  s_cselect_b32 s12, s6, s12
  s_lshl_b32 s12, s12, 12
  s_add_u32 m0, s8, 98304
  s_waitcnt vmcnt(8)
  s_barrier
  buffer_load_dwordx4 v23, s[60:63], s12 offen sc1 lds
  buffer_load_dwordx4 v23, s[60:63], s12 offen offset:1024 sc1 lds
  s_add_u32 s12, s14, 1
  s_sub_u32 s6, s12, 11
  s_cmp_ge_u32 s12, 11
  s_cselect_b32 s12, s6, s12
  s_lshl_b32 s12, s12, 12
  s_add_u32 m0, s8, 106496
  s_waitcnt vmcnt(8)
  s_barrier
  buffer_load_dwordx4 v23, s[60:63], s12 offen sc1 lds
  buffer_load_dwordx4 v23, s[60:63], s12 offen offset:1024 sc1 lds
  s_add_u32 s12, s14, 2
  s_sub_u32 s6, s12, 11
  s_cmp_ge_u32 s12, 11
  s_cselect_b32 s12, s6, s12
  s_lshl_b32 s12, s12, 12
  s_add_u32 m0, s8, 114688
  s_waitcnt vmcnt(8)
  s_barrier
  buffer_load_dwordx4 v23, s[60:63], s12 offen sc1 lds
  buffer_load_dwordx4 v23, s[60:63], s12 offen offset:1024 sc1 lds
  s_add_u32 s12, s14, 3
  s_sub_u32 s6, s12, 11
  s_cmp_ge_u32 s12, 11
  s_cselect_b32 s12, s6, s12
  s_lshl_b32 s12, s12, 12
  s_add_u32 m0, s8, 122880
  s_waitcnt vmcnt(8)
  s_barrier
  buffer_load_dwordx4 v23, s[60:63], s12 offen sc1 lds
  buffer_load_dwordx4 v23, s[60:63], s12 offen offset:1024 sc1 lds
  s_add_u32 s12, s14, 4
  s_sub_u32 s6, s12, 11
  s_cmp_ge_u32 s12, 11
  s_cselect_b32 s12, s6, s12
  s_lshl_b32 s12, s12, 12
  s_add_u32 m0, s8, 131072
  s_waitcnt vmcnt(8)
  s_barrier
  buffer_load_dwordx4 v23, s[60:63], s12 offen sc1 lds
  buffer_load_dwordx4 v23, s[60:63], s12 offen offset:1024 sc1 lds
  s_add_u32 s12, s14, 5
  s_sub_u32 s6, s12, 11
  s_cmp_ge_u32 s12, 11
  s_cselect_b32 s12, s6, s12
  s_lshl_b32 s12, s12, 12
  s_add_u32 m0, s8, 139264
  s_waitcnt vmcnt(8)
  s_barrier
  buffer_load_dwordx4 v23, s[60:63], s12 offen sc1 lds
  buffer_load_dwordx4 v23, s[60:63], s12 offen offset:1024 sc1 lds
  s_add_u32 s12, s14, 6
  s_sub_u32 s6, s12, 11
  s_cmp_ge_u32 s12, 11
  s_cselect_b32 s12, s6, s12
  s_lshl_b32 s12, s12, 12
  s_add_u32 m0, s8, 147456
  s_waitcnt vmcnt(8)
  s_barrier
  buffer_load_dwordx4 v23, s[60:63], s12 offen sc1 lds
  buffer_load_dwordx4 v23, s[60:63], s12 offen offset:1024 sc1 lds
  s_add_u32 s12, s14, 7
  s_sub_u32 s6, s12, 11
  s_cmp_ge_u32 s12, 11
  s_cselect_b32 s12, s6, s12
  s_lshl_b32 s12, s12, 12
  s_add_u32 m0, s8, 98304
  s_waitcnt vmcnt(8)
  s_barrier
  buffer_load_dwordx4 v23, s[60:63], s12 offen sc1 lds
  buffer_load_dwordx4 v23, s[60:63], s12 offen offset:1024 sc1 lds
  s_add_u32 s12, s14, 8
  s_sub_u32 s6, s12, 11
  s_cmp_ge_u32 s12, 11
  s_cselect_b32 s12, s6, s12
  s_lshl_b32 s12, s12, 12
  s_add_u32 m0, s8, 106496
  s_waitcnt vmcnt(8)
  s_barrier
  buffer_load_dwordx4 v23, s[60:63], s12 offen sc1 lds
  buffer_load_dwordx4 v23, s[60:63], s12 offen offset:1024 sc1 lds
  s_add_u32 s12, s14, 9
  s_sub_u32 s6, s12, 11
  s_cmp_ge_u32 s12, 11
  s_cselect_b32 s12, s6, s12
  s_lshl_b32 s12, s12, 12
  s_add_u32 m0, s8, 114688
  s_waitcnt vmcnt(8)
  s_barrier
  buffer_load_dwordx4 v23, s[60:63], s12 offen sc1 lds
  buffer_load_dwordx4 v23, s[60:63], s12 offen offset:1024 sc1 lds
  s_add_u32 s12, s14, 10
  s_sub_u32 s6, s12, 11
  s_cmp_ge_u32 s12, 11
  s_cselect_b32 s12, s6, s12
  s_lshl_b32 s12, s12, 12
  s_add_u32 m0, s8, 122880
  s_waitcnt vmcnt(8)
  s_barrier
  buffer_load_dwordx4 v23, s[60:63], s12 offen sc1 lds
  buffer_load_dwordx4 v23, s[60:63], s12 offen offset:1024 sc1 lds
  s_waitcnt vmcnt(8)
  s_barrier
  s_waitcnt vmcnt(6)
  s_barrier
  s_waitcnt vmcnt(4)
  s_barrier
  s_waitcnt vmcnt(2)
  s_barrier
  s_waitcnt vmcnt(0)
  s_barrier
  s_or_b32 s6, s87, s7
  s_cmp_lg_u32 s6, 0
  s_cbranch_scc1 L_p2_noep
  v_lshrrev_b32 v10, 4, v1
  v_and_b32 v17, 15, v1
  v_lshlrev_b32 v17, 2, v17
  v_lshl_add_u32 v17, v10, 9, v17
  buffer_load_dword v16, v17, s[88:91], 0 offen offset:256 sc1
  s_mov_b32 s15, 0
  s_waitcnt vmcnt(0)
L_p2c_poll:
  v_cmp_ne_u32 vcc, s86, v16
  s_cbranch_vccz L_p2c_go
  s_sleep 8
  buffer_load_dword v16, v17, s[88:91], 0 offen offset:256 sc1
  s_add_u32 s15, s15, 1
  s_cmp_lt_u32 s15, 0x20000
  s_waitcnt vmcnt(0)
  s_cbranch_scc1 L_p2c_poll
L_p2c_go:
  buffer_load_dword v16, v17, s[88:91], 0 offen offset:2304 sc1
  s_mov_b32 s15, 0
  s_waitcnt vmcnt(0)
L_p2d_poll:
  v_cmp_ne_u32 vcc, s86, v16
  s_cbranch_vccz L_p2d_go
  s_sleep 8
  buffer_load_dword v16, v17, s[88:91], 0 offen offset:2304 sc1
  s_add_u32 s15, s15, 1
  s_cmp_lt_u32 s15, 0x20000
  s_waitcnt vmcnt(0)
  s_cbranch_scc1 L_p2d_poll
L_p2d_go:
  s_cmp_lg_u32 s7, 0
  s_cbranch_scc1 L_p2_noep
  v_mov_b32 v10, s86
  v_mov_b32 v11, 0
  s_mov_b64 exec, 1
  buffer_store_dword v10, v11, s[76:79], 0 offen offset:0 sc1
  s_mov_b64 exec, -1
L_p2_noep:
  s_endpgm
L_Fmain:
  s_and_b32 s72, s7, 1
  s_lshr_b32 s73, s7, 1
  s_and_b32 s75, s4, 11
  s_lshr_b32 s6, s5, 3
  s_lshl_b32 s6, s6, 2
  s_add_u32 s75, s75, s6
  s_and_b32 s74, s4, 4
  s_and_b32 s6, s5, 3
  s_add_u32 s74, s74, s6
  s_bfe_u32 s6, s5, 0x10002
  s_lshl_b32 s75, s75, 1
  s_add_u32 s75, s75, s6
  s_lshl_b32 s75, s75, 1
  s_add_u32 s75, s75, s72
  s_lshl_b32 s75, s75, 16
  s_lshl_b32 s74, s74, 1
  s_add_u32 s74, s74, s73
  s_lshl_b32 s74, s74, 7
  s_add_u32 s75, s75, s74
  v_lshlrev_b32 v20, 15, v9
  v_lshl_add_u32 v20, v8, 2, v20
  v_add_u32 v20, s75, v20
  s_mov_b32 s68, s84
  s_mov_b32 s69, s85
  s_mov_b32 s70, 0x400000
  s_mov_b32 s71, 0x20000
  s_lshl_b32 s6, s72, 12
  s_add_u32 s6, s6, 98304
  v_add_u32 v17, s6, v6
  v_subrev_u32 v18, s8, v7
  s_lshl_b32 s6, s73, 12
  v_add_u32 v18, s6, v18
  v_bfe_u32 v10, v1, 2, 2
  v_lshlrev_b32 v19, 7, v10
  v_lshl_add_u32 v19, v9, 9, v19
  v_bfe_u32 v10, v1, 4, 1
  v_lshl_add_u32 v19, v10, 5, v19
  v_and_b32 v10, 3, v1
  v_lshl_add_u32 v19, v10, 3, v19
  v_bfe_u32 v10, v1, 3, 1
  v_xor_b32 v10, s73, v10
  v_lshl_add_u32 v19, v10, 6, v19
  s_lshl_b32 s6, s73, 6
  v_lshl_add_u32 v23, v8, 1, s6
  s_lshl_b32 s6, s72, 1
  v_add_u32 v10, s6, v9
  v_lshl_add_u32 v21, v10, 11, v23
  v_add_u32 v21, 98304, v21
  s_bfe_u32 s6, s5, 0x10002
  s_lshl_b32 s6, s6, 9
  s_add_u32 s6, s6, 155648
  v_lshl_add_u32 v22, v10, 7, s6
  v_add_u32 v23, 156672, v23
  s_lshl_b32 s100, s5, 2
  s_add_u32 s100, s100, s7
  s_lshl_b32 s100, s100, 12
  s_xor_b32 s101, s100, 0x10000
  v_bfe_u32 v10, v1, 4, 1
  v_mul_u32_u24 v11, 1152, v10
  v_lshl_add_u32 v11, v9, 8, v11
  v_bfe_u32 v10, v1, 2, 2
  v_lshl_add_u32 v11, v10, 5, v11
  v_and_b32 v10, 1, v1
  v_lshl_add_u32 v11, v10, 4, v11
  v_bfe_u32 v10, v1, 1, 1
  v_lshl_add_u32 v11, v10, 3, v11
  s_lshl_b32 s6, s72, 12
  s_add_u32 s6, s6, 98304
  v_add_u32 v11, s6, v11
  v_xor_b32 v10, 0x80, v11
  v_add_u32 v24, 98304, v7
  v_xor_b32 v25, 32, v24
  v_xor_b32 v26, 64, v24
  v_xor_b32 v27, 0x60, v24
  s_add_u32 s11, s83, 2
  s_and_b32 s11, s11, 7
  s_lshl_b32 s11, s11, 7
  s_add_u32 s12, s11, 8192
  s_add_u32 m0, s8, 122880
  s_waitcnt vmcnt(11)
  s_barrier
  buffer_load_dwordx4 v2, s[44:47], s11 offen lds
  s_add_u32 m0, s8, 123904
  s_nop 0
  buffer_load_dwordx4 v3, s[44:47], s11 offen lds
  ds_read_b128 a[0:3], v24
  s_add_u32 m0, s8, 124928
  s_nop 0
  buffer_load_dwordx4 v2, s[44:47], s12 offen lds
  ds_read_b128 a[4:7], v25
  s_add_u32 m0, s8, 125952
  s_nop 0
  buffer_load_dwordx4 v3, s[44:47], s12 offen lds
  ds_read_b128 a[8:11], v26
  s_add_u32 m0, s9, 139264
  s_nop 0
  buffer_load_dwordx4 v4, s[48:51], s11 offen lds
  ds_read_b128 a[12:15], v27
  s_add_u32 m0, s9, 143360
  s_nop 0
  buffer_load_dwordx4 v4, s[52:55], s11 offen lds
  s_waitcnt vmcnt(12)
  v_readfirstlane_b32 s86, v87
  v_mov_b32 v84, 0
  s_add_u32 s86, s86, 1
  s_bitset1_b32 s86, 31
  v_lshlrev_b32 v80, 16, v64
  v_and_b32 v81, 0xffff0000, v64
  v_lshlrev_b32 v82, 16, v72
  v_and_b32 v83, 0xffff0000, v72
  v_mul_f32 v80, v80, v82
  v_mul_f32 v81, v81, v83
  v_cvt_pk_bf16_f32 v80, v80, v81
  v_lshlrev_b32 v81, 16, v80
  v_and_b32 v80, 0xffff0000, v80
  v_add_f32 v84, v84, v81
  v_add_f32 v84, v84, v80
  v_lshlrev_b32 v80, 16, v65
  v_and_b32 v81, 0xffff0000, v65
  v_lshlrev_b32 v82, 16, v73
  v_and_b32 v83, 0xffff0000, v73
  v_mul_f32 v80, v80, v82
  v_mul_f32 v81, v81, v83
  v_cvt_pk_bf16_f32 v80, v80, v81
  v_lshlrev_b32 v81, 16, v80
  v_and_b32 v80, 0xffff0000, v80
  v_add_f32 v84, v84, v81
  v_add_f32 v84, v84, v80
  v_lshlrev_b32 v80, 16, v66
  v_and_b32 v81, 0xffff0000, v66
  v_lshlrev_b32 v82, 16, v74
  v_and_b32 v83, 0xffff0000, v74
  v_mul_f32 v80, v80, v82
  v_mul_f32 v81, v81, v83
  v_cvt_pk_bf16_f32 v80, v80, v81
  v_lshlrev_b32 v81, 16, v80
  v_and_b32 v80, 0xffff0000, v80
  v_add_f32 v84, v84, v81
  v_add_f32 v84, v84, v80
  v_lshlrev_b32 v80, 16, v67
  v_and_b32 v81, 0xffff0000, v67
  v_lshlrev_b32 v82, 16, v75
  v_and_b32 v83, 0xffff0000, v75
  v_mul_f32 v80, v80, v82
  v_mul_f32 v81, v81, v83
  v_cvt_pk_bf16_f32 v80, v80, v81
  v_lshlrev_b32 v81, 16, v80
  v_add_u32 v24, 0, v7
  v_xor_b32 v25, 32, v24
  v_xor_b32 v26, 64, v24
  v_xor_b32 v27, 0x60, v24
  s_add_u32 s11, s83, 3
  s_and_b32 s11, s11, 7
  s_lshl_b32 s11, s11, 7
  s_add_u32 s12, s11, 8192
  s_add_u32 m0, s8, 24576
  s_waitcnt vmcnt(6)
  s_barrier
  buffer_load_dwordx4 v2, s[44:47], s11 offen lds
  s_add_u32 m0, s8, 25600
  s_nop 0
  buffer_load_dwordx4 v3, s[44:47], s11 offen lds
  ds_read_b128 a[16:19], v24
  s_add_u32 m0, s8, 26624
  s_nop 0
  buffer_load_dwordx4 v2, s[44:47], s12 offen lds
  ds_read_b128 a[20:23], v25
  s_add_u32 m0, s8, 27648
  s_nop 0
  buffer_load_dwordx4 v3, s[44:47], s12 offen lds
  ds_read_b128 a[24:27], v26
  s_add_u32 m0, s9, 40960
  s_nop 0
  buffer_load_dwordx4 v4, s[48:51], s11 offen lds
  ds_read_b128 a[28:31], v27
  s_add_u32 m0, s9, 45056
  s_nop 0
  buffer_load_dwordx4 v4, s[52:55], s11 offen lds
  v_add_u32 v24, 122880, v7
  v_xor_b32 v25, 32, v24
  v_xor_b32 v26, 64, v24
  v_xor_b32 v27, 0x60, v24
  s_add_u32 s11, s83, 4
  s_and_b32 s11, s11, 7
  s_lshl_b32 s11, s11, 7
  s_add_u32 s12, s11, 8192
  s_add_u32 m0, s8, 98304
  s_waitcnt vmcnt(6)
  s_waitcnt lgkmcnt(4)
  s_barrier
  buffer_load_dwordx4 v2, s[44:47], s11 offen lds
  s_add_u32 m0, s8, 99328
  s_nop 0
  buffer_load_dwordx4 v3, s[44:47], s11 offen lds
  ds_read_b128 a[32:35], v24
  s_add_u32 m0, s8, 100352
  s_nop 0
  buffer_load_dwordx4 v2, s[44:47], s12 offen lds
  ds_read_b128 a[36:39], v25
  s_add_u32 m0, s8, 101376
  s_nop 0
  buffer_load_dwordx4 v3, s[44:47], s12 offen lds
  ds_read_b128 a[40:43], v26
  s_add_u32 m0, s9, 114688
  s_nop 0
  buffer_load_dwordx4 v4, s[48:51], s11 offen lds
  ds_read_b128 a[44:47], v27
  s_add_u32 m0, s9, 118784
  s_nop 0
  buffer_load_dwordx4 v4, s[52:55], s11 offen lds
  v_add_u32 v24, 24576, v7
  v_xor_b32 v25, 32, v24
  v_xor_b32 v26, 64, v24
  v_xor_b32 v27, 0x60, v24
  s_add_u32 s11, s83, 5
  s_and_b32 s11, s11, 7
  s_lshl_b32 s11, s11, 7
  s_add_u32 s12, s11, 8192
  s_add_u32 m0, s8, 0
  s_waitcnt vmcnt(6)
  s_waitcnt lgkmcnt(4)
  s_barrier
  buffer_load_dwordx4 v2, s[44:47], s11 offen lds
  s_add_u32 m0, s8, 1024
  s_nop 0
  buffer_load_dwordx4 v3, s[44:47], s11 offen lds
  ds_read_b128 a[48:51], v24
  s_add_u32 m0, s8, 2048
  s_nop 0
  buffer_load_dwordx4 v2, s[44:47], s12 offen lds
  ds_read_b128 a[52:55], v25
  s_add_u32 m0, s8, 3072
  s_nop 0
  buffer_load_dwordx4 v3, s[44:47], s12 offen lds
  ds_read_b128 a[56:59], v26
  s_add_u32 m0, s9, 16384
  s_nop 0
  buffer_load_dwordx4 v4, s[48:51], s11 offen lds
  ds_read_b128 a[60:63], v27
  s_add_u32 m0, s9, 20480
  s_nop 0
  buffer_load_dwordx4 v4, s[52:55], s11 offen lds
  v_add_u32 v24, 98304, v7
  v_xor_b32 v25, 32, v24
  v_xor_b32 v26, 64, v24
  v_xor_b32 v27, 0x60, v24
  s_add_u32 s11, s83, 6
  s_and_b32 s11, s11, 7
  s_lshl_b32 s11, s11, 7
  s_add_u32 s12, s11, 8192
  s_add_u32 m0, s8, 122880
  s_waitcnt vmcnt(6)
  s_waitcnt lgkmcnt(4)
  s_barrier
  buffer_load_dwordx4 v2, s[44:47], s11 offen lds
  s_add_u32 m0, s8, 123904
  s_nop 0
  buffer_load_dwordx4 v3, s[44:47], s11 offen lds
  ds_read_b128 a[64:67], v24
  s_add_u32 m0, s8, 124928
  s_nop 0
  buffer_load_dwordx4 v2, s[44:47], s12 offen lds
  ds_read_b128 a[68:71], v25
  s_add_u32 m0, s8, 125952
  s_nop 0
  buffer_load_dwordx4 v3, s[44:47], s12 offen lds
  ds_read_b128 a[72:75], v26
  s_add_u32 m0, s9, 139264
  s_nop 0
  buffer_load_dwordx4 v4, s[48:51], s11 offen lds
  ds_read_b128 a[76:79], v27
  s_add_u32 m0, s9, 143360
  s_nop 0
  buffer_load_dwordx4 v4, s[52:55], s11 offen lds
  v_add_u32 v24, 0, v7
  v_xor_b32 v25, 32, v24
  v_xor_b32 v26, 64, v24
  v_xor_b32 v27, 0x60, v24
  s_add_u32 s11, s83, 7
  s_and_b32 s11, s11, 7
  s_lshl_b32 s11, s11, 7
  s_add_u32 s12, s11, 8192
  s_add_u32 m0, s8, 24576
  s_waitcnt vmcnt(6)
  s_waitcnt lgkmcnt(4)
  s_barrier
  buffer_load_dwordx4 v2, s[44:47], s11 offen lds
  s_add_u32 m0, s8, 25600
  s_nop 0
  buffer_load_dwordx4 v3, s[44:47], s11 offen lds
  ds_read_b128 a[80:83], v24
  s_add_u32 m0, s8, 26624
  s_nop 0
  buffer_load_dwordx4 v2, s[44:47], s12 offen lds
  ds_read_b128 a[84:87], v25
  s_add_u32 m0, s8, 27648
  s_nop 0
  buffer_load_dwordx4 v3, s[44:47], s12 offen lds
  ds_read_b128 a[88:91], v26
  s_add_u32 m0, s9, 40960
  s_nop 0
  buffer_load_dwordx4 v4, s[48:51], s11 offen lds
  ds_read_b128 a[92:95], v27
  s_add_u32 m0, s9, 45056
  s_nop 0
  buffer_load_dwordx4 v4, s[52:55], s11 offen lds
  v_add_u32 v24, 122880, v7
  v_xor_b32 v25, 32, v24
  v_xor_b32 v26, 64, v24
  v_xor_b32 v27, 0x60, v24
  s_add_u32 s11, s83, 0
  s_and_b32 s11, s11, 7
  s_mul_i32 s11, s11, 176128
  s_add_u32 m0, s10, 49152
  s_waitcnt vmcnt(6)
  s_waitcnt lgkmcnt(4)
  s_barrier
  buffer_load_dwordx4 v5, s[56:59], s11 offen offset:0 lds
  s_add_u32 m0, s10, 50112
  s_add_u32 s12, s11, s92
  buffer_load_dwordx4 v5, s[56:59], s12 offen offset:64 lds
  ds_read_b128 a[96:99], v24
  s_add_u32 m0, s10, 51072
  s_add_u32 s12, s11, s93
  buffer_load_dwordx4 v5, s[56:59], s12 offen offset:128 lds
  ds_read_b128 a[100:103], v25
  s_add_u32 m0, s10, 52224
  s_nop 0
  buffer_load_dwordx4 v16, s[60:63], s11 offen offset:0 lds
  ds_read_b128 a[104:107], v26
  s_add_u32 m0, s10, 53184
  s_add_u32 s12, s11, s92
  buffer_load_dwordx4 v16, s[60:63], s12 offen offset:64 lds
  ds_read_b128 a[108:111], v27
  s_add_u32 m0, s10, 54144
  s_add_u32 s12, s11, s93
  buffer_load_dwordx4 v16, s[60:63], s12 offen offset:128 lds
  v_add_u32 v24, 24576, v7
  v_xor_b32 v25, 32, v24
  v_xor_b32 v26, 64, v24
  v_xor_b32 v27, 0x60, v24
  s_add_u32 s11, s83, 1
  s_and_b32 s11, s11, 7
  s_mul_i32 s11, s11, 176128
  s_add_u32 m0, s10, 73728
  s_waitcnt vmcnt(6)
  s_waitcnt lgkmcnt(4)
  s_barrier
  buffer_load_dwordx4 v5, s[56:59], s11 offen offset:0 lds
  s_add_u32 m0, s10, 74688
  s_add_u32 s12, s11, s92
  buffer_load_dwordx4 v5, s[56:59], s12 offen offset:64 lds
  ds_read_b128 a[112:115], v24
  s_add_u32 m0, s10, 75648
  s_add_u32 s12, s11, s93
  buffer_load_dwordx4 v5, s[56:59], s12 offen offset:128 lds
  ds_read_b128 a[116:119], v25
  s_add_u32 m0, s10, 76800
  s_nop 0
  buffer_load_dwordx4 v16, s[60:63], s11 offen offset:0 lds
  ds_read_b128 a[120:123], v26
  s_add_u32 m0, s10, 77760
  s_add_u32 s12, s11, s92
  buffer_load_dwordx4 v16, s[60:63], s12 offen offset:64 lds
  ds_read_b128 a[124:127], v27
  s_add_u32 m0, s10, 78720
  s_add_u32 s12, s11, s93
  buffer_load_dwordx4 v16, s[60:63], s12 offen offset:128 lds
  v_and_b32 v80, 0xffff0000, v80
  v_add_f32 v84, v84, v81
  v_add_f32 v84, v84, v80
  v_lshlrev_b32 v80, 16, v68
  v_and_b32 v81, 0xffff0000, v68
  v_lshlrev_b32 v82, 16, v76
  v_and_b32 v83, 0xffff0000, v76
  v_mul_f32 v80, v80, v82
  v_mul_f32 v81, v81, v83
  v_cvt_pk_bf16_f32 v80, v80, v81
  v_lshlrev_b32 v81, 16, v80
  v_and_b32 v80, 0xffff0000, v80
  v_add_f32 v84, v84, v81
  v_add_f32 v84, v84, v80
  v_lshlrev_b32 v80, 16, v69
  v_and_b32 v81, 0xffff0000, v69
  v_lshlrev_b32 v82, 16, v77
  v_and_b32 v83, 0xffff0000, v77
  v_mul_f32 v80, v80, v82
  v_mul_f32 v81, v81, v83
  v_cvt_pk_bf16_f32 v80, v80, v81
  v_lshlrev_b32 v81, 16, v80
  v_and_b32 v80, 0xffff0000, v80
  v_add_f32 v84, v84, v81
  v_add_f32 v84, v84, v80
  v_lshlrev_b32 v80, 16, v70
  v_and_b32 v81, 0xffff0000, v70
  v_lshlrev_b32 v82, 16, v78
  v_and_b32 v83, 0xffff0000, v78
  v_mul_f32 v80, v80, v82
  v_mul_f32 v81, v81, v83
  v_cvt_pk_bf16_f32 v80, v80, v81
  v_lshlrev_b32 v81, 16, v80
  v_and_b32 v80, 0xffff0000, v80
  v_add_f32 v84, v84, v81
  v_add_f32 v84, v84, v80
  v_lshlrev_b32 v80, 16, v71
  v_and_b32 v81, 0xffff0000, v71
  v_lshlrev_b32 v82, 16, v79
  v_and_b32 v83, 0xffff0000, v79
  v_mul_f32 v80, v80, v82
  v_mul_f32 v81, v81, v83
  v_cvt_pk_bf16_f32 v80, v80, v81
  v_lshlrev_b32 v81, 16, v80
  v_and_b32 v80, 0xffff0000, v80
  v_add_f32 v84, v84, v81
  v_add_f32 v84, v84, v80
  s_nop 1
  v_add_f32_dpp v84, v84, v84 row_shr:1 row_mask:0xf bank_mask:0xf bound_ctrl:0
  s_nop 1
  v_add_f32_dpp v84, v84, v84 row_shr:2 row_mask:0xf bank_mask:0xf bound_ctrl:0
  s_nop 1
  v_add_f32_dpp v84, v84, v84 row_shr:4 row_mask:0xf bank_mask:0xf bound_ctrl:0
  s_nop 1
  v_add_f32_dpp v84, v84, v84 row_shr:8 row_mask:0xf bank_mask:0xf bound_ctrl:0
  s_nop 1
  v_add_f32_dpp v84, v84, v84 row_bcast:15 row_mask:0xa bank_mask:0xf
  v_cvt_pk_bf16_f32 v84, v84, v84
  v_and_b32 v84, 0xffff0000, v84
  v_mul_f32 v84, s80, v84
  v_exp_f32 v84, v84
  s_nop 0
  v_add_f32 v84, 1.0, v84
  v_rcp_f32 v84, v84
  s_nop 0
  v_cvt_pk_bf16_f32 v84, v84, v84
  v_and_b32 v84, 0xffff0000, v84
  v_sub_f32 v85, 1.0, v84
  v_cvt_pk_bf16_f32 v85, v85, v85
  v_and_b32 v85, 0xffff0000, v85
  s_lshl_b32 s6, s4, 7
  s_add_u32 s6, s6, s13
  s_lshl_b32 s6, s6, 3
  v_lshlrev_b32 v86, 3, v9
  s_mov_b32 exec_lo, 0x80000000
  s_mov_b32 exec_hi, 0x80000000
  buffer_store_dwordx2 v[84:85], v86, s[76:79], s6 offen sc0 sc1
  s_mov_b64 exec, -1
  s_lshl_b32 s6, s4, 18
  s_add_u32 s6, s6, 0xc00000
  s_add_u32 s88, s42, s6
  s_addc_u32 s89, s43, 0
  s_mov_b32 s90, 0x40000
  s_mov_b32 s91, 0x20000
  v_add_u32 v30, 49152, v12
  v_add_u32 v31, 49152, v13
  s_waitcnt vmcnt(7)
  s_waitcnt lgkmcnt(4)
  s_barrier
  ds_read_b64_tr_b16 v[32:33], v30 offset:1024
  ds_read_b64_tr_b16 v[34:35], v30 offset:1280
  ds_read_b64_tr_b16 v[36:37], v31 offset:1024
  ds_read_b64_tr_b16 v[38:39], v31 offset:1280
  ds_read_b64_tr_b16 v[40:41], v30 offset:2048
  ds_read_b64_tr_b16 v[42:43], v30 offset:2304
  ds_read_b64_tr_b16 v[44:45], v31 offset:2048
  ds_read_b64_tr_b16 v[46:47], v31 offset:2304
  ds_read_b64_tr_b16 v[48:49], v30 offset:7168
  ds_read_b64_tr_b16 v[50:51], v30 offset:7424
  ds_read_b64_tr_b16 v[52:53], v31 offset:7168
  ds_read_b64_tr_b16 v[54:55], v31 offset:7424
  s_waitcnt lgkmcnt(10)
  v_mfma_f32_32x32x16_bf16 v[64:79], v[32:35], a[0:3], 0
  s_add_u32 s11, s83, 2
  s_and_b32 s11, s11, 7
  s_mul_i32 s11, s11, 176128
  s_add_u32 m0, s10, 101376
  s_nop 0
  buffer_load_dwordx4 v16, s[60:63], s11 offen offset:0 lds
  s_waitcnt lgkmcnt(8)
  v_mfma_f32_32x32x16_bf16 v[80:95], v[36:39], a[0:3], 0
  ds_read_b64_tr_b16 v[56:57], v30 offset:8192
  ds_read_b64_tr_b16 v[58:59], v30 offset:8448
  s_waitcnt lgkmcnt(8)
  v_mfma_f32_32x32x16_bf16 v[96:111], v[40:43], a[0:3], 0
  ds_read_b64_tr_b16 v[60:61], v31 offset:8192
  ds_read_b64_tr_b16 v[62:63], v31 offset:8448
  s_waitcnt lgkmcnt(8)
  v_mfma_f32_32x32x16_bf16 v[112:127], v[44:47], a[0:3], 0
  ds_read_b64_tr_b16 v[32:33], v30 offset:13312
  ds_read_b64_tr_b16 v[34:35], v30 offset:13568
  s_waitcnt lgkmcnt(8)
  v_mfma_f32_32x32x16_bf16 v[64:79], v[48:51], a[4:7], v[64:79]
  s_add_u32 m0, s10, 102336
  s_add_u32 s12, s11, s92
  buffer_load_dwordx4 v16, s[60:63], s12 offen offset:64 lds
  ds_read_b64_tr_b16 v[36:37], v31 offset:13312
  ds_read_b64_tr_b16 v[38:39], v31 offset:13568
  s_waitcnt lgkmcnt(8)
  v_mfma_f32_32x32x16_bf16 v[80:95], v[52:55], a[4:7], v[80:95]
  ds_read_b64_tr_b16 v[40:41], v30 offset:14336
  ds_read_b64_tr_b16 v[42:43], v30 offset:14592
  s_waitcnt lgkmcnt(8)
  v_mfma_f32_32x32x16_bf16 v[96:111], v[56:59], a[4:7], v[96:111]
  ds_read_b64_tr_b16 v[44:45], v31 offset:14336
  ds_read_b64_tr_b16 v[46:47], v31 offset:14592
  s_waitcnt lgkmcnt(8)
  v_mfma_f32_32x32x16_bf16 v[112:127], v[60:63], a[4:7], v[112:127]
  ds_read_b64_tr_b16 v[48:49], v30 offset:19456
  ds_read_b64_tr_b16 v[50:51], v30 offset:19712
  s_waitcnt lgkmcnt(8)
  v_mfma_f32_32x32x16_bf16 v[64:79], v[32:35], a[8:11], v[64:79]
  s_add_u32 m0, s10, 103296
  s_add_u32 s12, s11, s93
  buffer_load_dwordx4 v16, s[60:63], s12 offen offset:128 lds
  ds_read_b64_tr_b16 v[52:53], v31 offset:19456
  ds_read_b64_tr_b16 v[54:55], v31 offset:19712
  s_waitcnt lgkmcnt(8)
  v_mfma_f32_32x32x16_bf16 v[80:95], v[36:39], a[8:11], v[80:95]
  ds_read_b64_tr_b16 v[56:57], v30 offset:20480
  ds_read_b64_tr_b16 v[58:59], v30 offset:20736
  s_waitcnt lgkmcnt(8)
  v_mfma_f32_32x32x16_bf16 v[96:111], v[40:43], a[8:11], v[96:111]
  ds_read_b64_tr_b16 v[60:61], v31 offset:20480
  ds_read_b64_tr_b16 v[62:63], v31 offset:20736
  s_waitcnt lgkmcnt(8)
  v_mfma_f32_32x32x16_bf16 v[112:127], v[44:47], a[8:11], v[112:127]
  v_add_u32 v14, 73728, v12
  v_add_u32 v15, 73728, v13
  s_waitcnt vmcnt(4)
  s_barrier
  ds_read_b64_tr_b16 v[32:33], v14 offset:1024
  ds_read_b64_tr_b16 v[34:35], v14 offset:1280
  s_waitcnt lgkmcnt(8)
  v_mfma_f32_32x32x16_bf16 v[64:79], v[48:51], a[12:15], v[64:79]
  s_add_u32 s11, s83, 3
  s_and_b32 s11, s11, 7
  s_mul_i32 s11, s11, 176128
  s_add_u32 m0, s10, 3072
  s_nop 0
  buffer_load_dwordx4 v16, s[60:63], s11 offen offset:0 lds
  ds_read_b64_tr_b16 v[36:37], v15 offset:1024
  ds_read_b64_tr_b16 v[38:39], v15 offset:1280
  s_waitcnt lgkmcnt(8)
  v_mfma_f32_32x32x16_bf16 v[80:95], v[52:55], a[12:15], v[80:95]
  ds_read_b64_tr_b16 v[40:41], v14 offset:2048
  ds_read_b64_tr_b16 v[42:43], v14 offset:2304
  s_waitcnt lgkmcnt(8)
  v_mfma_f32_32x32x16_bf16 v[96:111], v[56:59], a[12:15], v[96:111]
  ds_read_b64_tr_b16 v[44:45], v15 offset:2048
  ds_read_b64_tr_b16 v[46:47], v15 offset:2304
  s_waitcnt lgkmcnt(8)
  v_mfma_f32_32x32x16_bf16 v[112:127], v[60:63], a[12:15], v[112:127]
  ds_read_b64_tr_b16 v[48:49], v14 offset:7168
  ds_read_b64_tr_b16 v[50:51], v14 offset:7424
  s_waitcnt lgkmcnt(8)
  v_mfma_f32_32x32x16_bf16 v[64:79], v[32:35], a[16:19], v[64:79]
  s_add_u32 m0, s10, 4032
  s_add_u32 s12, s11, s92
  buffer_load_dwordx4 v16, s[60:63], s12 offen offset:64 lds
  ds_read_b64_tr_b16 v[52:53], v15 offset:7168
  ds_read_b64_tr_b16 v[54:55], v15 offset:7424
  s_waitcnt lgkmcnt(8)
  v_mfma_f32_32x32x16_bf16 v[80:95], v[36:39], a[16:19], v[80:95]
  ds_read_b64_tr_b16 v[56:57], v14 offset:8192
  ds_read_b64_tr_b16 v[58:59], v14 offset:8448
  s_waitcnt lgkmcnt(8)
  v_mfma_f32_32x32x16_bf16 v[96:111], v[40:43], a[16:19], v[96:111]
  ds_read_b64_tr_b16 v[60:61], v15 offset:8192
  ds_read_b64_tr_b16 v[62:63], v15 offset:8448
  s_waitcnt lgkmcnt(8)
  v_mfma_f32_32x32x16_bf16 v[112:127], v[44:47], a[16:19], v[112:127]
  ds_read_b64_tr_b16 v[32:33], v14 offset:13312
  ds_read_b64_tr_b16 v[34:35], v14 offset:13568
  s_waitcnt lgkmcnt(8)
  v_mfma_f32_32x32x16_bf16 v[64:79], v[48:51], a[20:23], v[64:79]
  s_add_u32 m0, s10, 4992
  s_add_u32 s12, s11, s93
  buffer_load_dwordx4 v16, s[60:63], s12 offen offset:128 lds
  ds_read_b64_tr_b16 v[36:37], v15 offset:13312
  ds_read_b64_tr_b16 v[38:39], v15 offset:13568
  s_waitcnt lgkmcnt(8)
  v_mfma_f32_32x32x16_bf16 v[80:95], v[52:55], a[20:23], v[80:95]
  ds_read_b64_tr_b16 v[40:41], v14 offset:14336
  ds_read_b64_tr_b16 v[42:43], v14 offset:14592
  s_waitcnt lgkmcnt(8)
  v_mfma_f32_32x32x16_bf16 v[96:111], v[56:59], a[20:23], v[96:111]
  ds_read_b64_tr_b16 v[44:45], v15 offset:14336
  ds_read_b64_tr_b16 v[46:47], v15 offset:14592
  s_waitcnt lgkmcnt(8)
  v_mfma_f32_32x32x16_bf16 v[112:127], v[60:63], a[20:23], v[112:127]
  ds_read_b64_tr_b16 v[48:49], v14 offset:19456
  ds_read_b64_tr_b16 v[50:51], v14 offset:19712
  s_waitcnt lgkmcnt(8)
  v_mfma_f32_32x32x16_bf16 v[64:79], v[32:35], a[24:27], v[64:79]
  s_add_u32 s11, s83, 4
  s_and_b32 s11, s11, 7
  s_mul_i32 s11, s11, 176128
  s_add_u32 m0, s10, 125952
  s_nop 0
  buffer_load_dwordx4 v16, s[60:63], s11 offen offset:0 lds
  ds_read_b64_tr_b16 v[52:53], v15 offset:19456
  ds_read_b64_tr_b16 v[54:55], v15 offset:19712
  s_waitcnt lgkmcnt(8)
  v_mfma_f32_32x32x16_bf16 v[80:95], v[36:39], a[24:27], v[80:95]
  ds_read_b64_tr_b16 v[56:57], v14 offset:20480
  ds_read_b64_tr_b16 v[58:59], v14 offset:20736
  s_waitcnt lgkmcnt(8)
  v_mfma_f32_32x32x16_bf16 v[96:111], v[40:43], a[24:27], v[96:111]
  ds_read_b64_tr_b16 v[60:61], v15 offset:20480
  ds_read_b64_tr_b16 v[62:63], v15 offset:20736
  s_waitcnt lgkmcnt(8)
  v_mfma_f32_32x32x16_bf16 v[112:127], v[44:47], a[24:27], v[112:127]
  s_waitcnt vmcnt(7)
  v_add_u32 v28, 98304, v12
  v_add_u32 v29, 98304, v13
  s_waitcnt vmcnt(4)
  s_barrier
  ds_read_b64_tr_b16 v[32:33], v28 offset:1024
  ds_read_b64_tr_b16 v[34:35], v28 offset:1280
  s_waitcnt lgkmcnt(8)
  v_mfma_f32_32x32x16_bf16 v[64:79], v[48:51], a[28:31], v[64:79]
  s_add_u32 m0, s10, 126912
  s_add_u32 s12, s11, s92
  buffer_load_dwordx4 v16, s[60:63], s12 offen offset:64 lds
  ds_read_b64_tr_b16 v[36:37], v29 offset:1024
  ds_read_b64_tr_b16 v[38:39], v29 offset:1280
  s_waitcnt lgkmcnt(8)
  v_mfma_f32_32x32x16_bf16 v[80:95], v[52:55], a[28:31], v[80:95]
  ds_read_b64_tr_b16 v[40:41], v28 offset:2048
  ds_read_b64_tr_b16 v[42:43], v28 offset:2304
  s_waitcnt lgkmcnt(8)
  v_mfma_f32_32x32x16_bf16 v[96:111], v[56:59], a[28:31], v[96:111]
  ds_read_b64_tr_b16 v[44:45], v29 offset:2048
  ds_read_b64_tr_b16 v[46:47], v29 offset:2304
  s_waitcnt lgkmcnt(8)
  v_mfma_f32_32x32x16_bf16 v[112:127], v[60:63], a[28:31], v[112:127]
  ds_read_b64_tr_b16 v[48:49], v28 offset:7168
  ds_read_b64_tr_b16 v[50:51], v28 offset:7424
  s_waitcnt lgkmcnt(8)
  v_mfma_f32_32x32x16_bf16 v[64:79], v[32:35], a[32:35], v[64:79]
  s_add_u32 m0, s10, 127872
  s_add_u32 s12, s11, s93
  buffer_load_dwordx4 v16, s[60:63], s12 offen offset:128 lds
  ds_read_b64_tr_b16 v[52:53], v29 offset:7168
  ds_read_b64_tr_b16 v[54:55], v29 offset:7424
  s_waitcnt lgkmcnt(8)
  v_mfma_f32_32x32x16_bf16 v[80:95], v[36:39], a[32:35], v[80:95]
  ds_read_b64_tr_b16 v[56:57], v28 offset:8192
  ds_read_b64_tr_b16 v[58:59], v28 offset:8448
  s_waitcnt lgkmcnt(8)
  v_mfma_f32_32x32x16_bf16 v[96:111], v[40:43], a[32:35], v[96:111]
  ds_read_b64_tr_b16 v[60:61], v29 offset:8192
  ds_read_b64_tr_b16 v[62:63], v29 offset:8448
  s_waitcnt lgkmcnt(8)
  v_mfma_f32_32x32x16_bf16 v[112:127], v[44:47], a[32:35], v[112:127]
  ds_read_b64_tr_b16 v[32:33], v28 offset:13312
  ds_read_b64_tr_b16 v[34:35], v28 offset:13568
  s_waitcnt lgkmcnt(8)
  v_mfma_f32_32x32x16_bf16 v[64:79], v[48:51], a[36:39], v[64:79]
  s_add_u32 s11, s83, 5
  s_and_b32 s11, s11, 7
  s_mul_i32 s11, s11, 176128
  s_add_u32 m0, s10, 27648
  s_nop 0
  buffer_load_dwordx4 v16, s[60:63], s11 offen offset:0 lds
  ds_read_b64_tr_b16 v[36:37], v29 offset:13312
  ds_read_b64_tr_b16 v[38:39], v29 offset:13568
  s_waitcnt lgkmcnt(8)
  v_mfma_f32_32x32x16_bf16 v[80:95], v[52:55], a[36:39], v[80:95]
  ds_read_b64_tr_b16 v[40:41], v28 offset:14336
  ds_read_b64_tr_b16 v[42:43], v28 offset:14592
  s_waitcnt lgkmcnt(8)
  v_mfma_f32_32x32x16_bf16 v[96:111], v[56:59], a[36:39], v[96:111]
  ds_read_b64_tr_b16 v[44:45], v29 offset:14336
  ds_read_b64_tr_b16 v[46:47], v29 offset:14592
  s_waitcnt lgkmcnt(8)
  v_mfma_f32_32x32x16_bf16 v[112:127], v[60:63], a[36:39], v[112:127]
  ds_read_b64_tr_b16 v[48:49], v28 offset:19456
  ds_read_b64_tr_b16 v[50:51], v28 offset:19712
  s_waitcnt lgkmcnt(8)
  v_mfma_f32_32x32x16_bf16 v[64:79], v[32:35], a[40:43], v[64:79]
  s_add_u32 m0, s10, 28608
  s_add_u32 s12, s11, s92
  buffer_load_dwordx4 v16, s[60:63], s12 offen offset:64 lds
  ds_read_b64_tr_b16 v[52:53], v29 offset:19456
  ds_read_b64_tr_b16 v[54:55], v29 offset:19712
  s_waitcnt lgkmcnt(8)
  v_mfma_f32_32x32x16_bf16 v[80:95], v[36:39], a[40:43], v[80:95]
  ds_read_b64_tr_b16 v[56:57], v28 offset:20480
  ds_read_b64_tr_b16 v[58:59], v28 offset:20736
  s_waitcnt lgkmcnt(8)
  v_mfma_f32_32x32x16_bf16 v[96:111], v[40:43], a[40:43], v[96:111]
  ds_read_b64_tr_b16 v[60:61], v29 offset:20480
  ds_read_b64_tr_b16 v[62:63], v29 offset:20736
  s_waitcnt lgkmcnt(8)
  v_mfma_f32_32x32x16_bf16 v[112:127], v[44:47], a[40:43], v[112:127]
  v_add_u32 v30, 0, v12
  v_add_u32 v31, 0, v13
  s_waitcnt vmcnt(5)
  s_barrier
  ds_read_b64_tr_b16 v[32:33], v30 offset:1024
  ds_read_b64_tr_b16 v[34:35], v30 offset:1280
  s_waitcnt lgkmcnt(8)
  v_mfma_f32_32x32x16_bf16 v[64:79], v[48:51], a[44:47], v[64:79]
  s_add_u32 m0, s10, 29568
  s_add_u32 s12, s11, s93
  buffer_load_dwordx4 v16, s[60:63], s12 offen offset:128 lds
  ds_read_b64_tr_b16 v[36:37], v31 offset:1024
  ds_read_b64_tr_b16 v[38:39], v31 offset:1280
  s_waitcnt lgkmcnt(8)
  v_mfma_f32_32x32x16_bf16 v[80:95], v[52:55], a[44:47], v[80:95]
  ds_read_b64_tr_b16 v[40:41], v30 offset:2048
  ds_read_b64_tr_b16 v[42:43], v30 offset:2304
  s_waitcnt lgkmcnt(8)
  v_mfma_f32_32x32x16_bf16 v[96:111], v[56:59], a[44:47], v[96:111]
  ds_read_b64_tr_b16 v[44:45], v31 offset:2048
  ds_read_b64_tr_b16 v[46:47], v31 offset:2304
  s_waitcnt lgkmcnt(8)
  v_mfma_f32_32x32x16_bf16 v[112:127], v[60:63], a[44:47], v[112:127]
  ds_read_b64_tr_b16 v[48:49], v30 offset:7168
  ds_read_b64_tr_b16 v[50:51], v30 offset:7424
  s_waitcnt lgkmcnt(8)
  v_mfma_f32_32x32x16_bf16 v[64:79], v[32:35], a[48:51], v[64:79]
  s_add_u32 s11, s83, 6
  s_and_b32 s11, s11, 7
  s_mul_i32 s11, s11, 176128
  s_add_u32 m0, s10, 52224
  s_nop 0
  buffer_load_dwordx4 v16, s[60:63], s11 offen offset:0 lds
  ds_read_b64_tr_b16 v[52:53], v31 offset:7168
  ds_read_b64_tr_b16 v[54:55], v31 offset:7424
  s_waitcnt lgkmcnt(8)
  v_mfma_f32_32x32x16_bf16 v[80:95], v[36:39], a[48:51], v[80:95]
  ds_read_b64_tr_b16 v[56:57], v30 offset:8192
  ds_read_b64_tr_b16 v[58:59], v30 offset:8448
  s_waitcnt lgkmcnt(8)
  v_mfma_f32_32x32x16_bf16 v[96:111], v[40:43], a[48:51], v[96:111]
  ds_read_b64_tr_b16 v[60:61], v31 offset:8192
  ds_read_b64_tr_b16 v[62:63], v31 offset:8448
  s_waitcnt lgkmcnt(8)
  v_mfma_f32_32x32x16_bf16 v[112:127], v[44:47], a[48:51], v[112:127]
  ds_read_b64_tr_b16 v[32:33], v30 offset:13312
  ds_read_b64_tr_b16 v[34:35], v30 offset:13568
  s_waitcnt lgkmcnt(8)
  v_mfma_f32_32x32x16_bf16 v[64:79], v[48:51], a[52:55], v[64:79]
  s_add_u32 m0, s10, 53184
  s_add_u32 s12, s11, s92
  buffer_load_dwordx4 v16, s[60:63], s12 offen offset:64 lds
  ds_read_b64_tr_b16 v[36:37], v31 offset:13312
  ds_read_b64_tr_b16 v[38:39], v31 offset:13568
  s_waitcnt lgkmcnt(8)
  v_mfma_f32_32x32x16_bf16 v[80:95], v[52:55], a[52:55], v[80:95]
  ds_read_b64_tr_b16 v[40:41], v30 offset:14336
  ds_read_b64_tr_b16 v[42:43], v30 offset:14592
  s_waitcnt lgkmcnt(8)
  v_mfma_f32_32x32x16_bf16 v[96:111], v[56:59], a[52:55], v[96:111]
  ds_read_b64_tr_b16 v[44:45], v31 offset:14336
  ds_read_b64_tr_b16 v[46:47], v31 offset:14592
  s_waitcnt lgkmcnt(8)
  v_mfma_f32_32x32x16_bf16 v[112:127], v[60:63], a[52:55], v[112:127]
  ds_read_b64_tr_b16 v[48:49], v30 offset:19456
  ds_read_b64_tr_b16 v[50:51], v30 offset:19712
  s_waitcnt lgkmcnt(8)
  v_mfma_f32_32x32x16_bf16 v[64:79], v[32:35], a[56:59], v[64:79]
  s_add_u32 m0, s10, 54144
  s_add_u32 s12, s11, s93
  buffer_load_dwordx4 v16, s[60:63], s12 offen offset:128 lds
  ds_read_b64_tr_b16 v[52:53], v31 offset:19456
  ds_read_b64_tr_b16 v[54:55], v31 offset:19712
  s_waitcnt lgkmcnt(8)
  v_mfma_f32_32x32x16_bf16 v[80:95], v[36:39], a[56:59], v[80:95]
  ds_read_b64_tr_b16 v[56:57], v30 offset:20480
  ds_read_b64_tr_b16 v[58:59], v30 offset:20736
  s_waitcnt lgkmcnt(8)
  v_mfma_f32_32x32x16_bf16 v[96:111], v[40:43], a[56:59], v[96:111]
  ds_read_b64_tr_b16 v[60:61], v31 offset:20480
  ds_read_b64_tr_b16 v[62:63], v31 offset:20736
  s_waitcnt lgkmcnt(8)
  v_mfma_f32_32x32x16_bf16 v[112:127], v[44:47], a[56:59], v[112:127]
  v_add_u32 v14, 122880, v12
  v_add_u32 v15, 122880, v13
  s_waitcnt vmcnt(6)
  s_barrier
  ds_read_b64_tr_b16 v[32:33], v14 offset:1024
  ds_read_b64_tr_b16 v[34:35], v14 offset:1280
  s_waitcnt lgkmcnt(8)
  v_mfma_f32_32x32x16_bf16 v[64:79], v[48:51], a[60:63], v[64:79]
  s_add_u32 s11, s83, 7
  s_and_b32 s11, s11, 7
  s_mul_i32 s11, s11, 176128
  s_add_u32 m0, s10, 76800
  s_nop 0
  buffer_load_dwordx4 v16, s[60:63], s11 offen offset:0 lds
  ds_read_b64_tr_b16 v[36:37], v15 offset:1024
  ds_read_b64_tr_b16 v[38:39], v15 offset:1280
  s_waitcnt lgkmcnt(8)
  v_mfma_f32_32x32x16_bf16 v[80:95], v[52:55], a[60:63], v[80:95]
  ds_read_b64_tr_b16 v[40:41], v14 offset:2048
  ds_read_b64_tr_b16 v[42:43], v14 offset:2304
  s_waitcnt lgkmcnt(8)
  v_mfma_f32_32x32x16_bf16 v[96:111], v[56:59], a[60:63], v[96:111]
  ds_read_b64_tr_b16 v[44:45], v15 offset:2048
  ds_read_b64_tr_b16 v[46:47], v15 offset:2304
  s_waitcnt lgkmcnt(8)
  v_mfma_f32_32x32x16_bf16 v[112:127], v[60:63], a[60:63], v[112:127]
  ds_read_b64_tr_b16 v[48:49], v14 offset:7168
  ds_read_b64_tr_b16 v[50:51], v14 offset:7424
  s_waitcnt lgkmcnt(8)
  v_mfma_f32_32x32x16_bf16 v[64:79], v[32:35], a[64:67], v[64:79]
  s_add_u32 m0, s10, 77760
  s_add_u32 s12, s11, s92
  buffer_load_dwordx4 v16, s[60:63], s12 offen offset:64 lds
  ds_read_b64_tr_b16 v[52:53], v15 offset:7168
  ds_read_b64_tr_b16 v[54:55], v15 offset:7424
  s_waitcnt lgkmcnt(8)
  v_mfma_f32_32x32x16_bf16 v[80:95], v[36:39], a[64:67], v[80:95]
  ds_read_b64_tr_b16 v[56:57], v14 offset:8192
  ds_read_b64_tr_b16 v[58:59], v14 offset:8448
  s_waitcnt lgkmcnt(8)
  v_mfma_f32_32x32x16_bf16 v[96:111], v[40:43], a[64:67], v[96:111]
  ds_read_b64_tr_b16 v[60:61], v15 offset:8192
  ds_read_b64_tr_b16 v[62:63], v15 offset:8448
  s_waitcnt lgkmcnt(8)
  v_mfma_f32_32x32x16_bf16 v[112:127], v[44:47], a[64:67], v[112:127]
  ds_read_b64_tr_b16 v[32:33], v14 offset:13312
  ds_read_b64_tr_b16 v[34:35], v14 offset:13568
  s_waitcnt lgkmcnt(8)
  v_mfma_f32_32x32x16_bf16 v[64:79], v[48:51], a[68:71], v[64:79]
  s_add_u32 m0, s10, 78720
  s_add_u32 s12, s11, s93
  buffer_load_dwordx4 v16, s[60:63], s12 offen offset:128 lds
  ds_read_b64_tr_b16 v[36:37], v15 offset:13312
  ds_read_b64_tr_b16 v[38:39], v15 offset:13568
  s_waitcnt lgkmcnt(8)
  v_mfma_f32_32x32x16_bf16 v[80:95], v[52:55], a[68:71], v[80:95]
  ds_read_b64_tr_b16 v[40:41], v14 offset:14336
  ds_read_b64_tr_b16 v[42:43], v14 offset:14592
  s_waitcnt lgkmcnt(8)
  v_mfma_f32_32x32x16_bf16 v[96:111], v[56:59], a[68:71], v[96:111]
  ds_read_b64_tr_b16 v[44:45], v15 offset:14336
  ds_read_b64_tr_b16 v[46:47], v15 offset:14592
  s_waitcnt lgkmcnt(8)
  v_mfma_f32_32x32x16_bf16 v[112:127], v[60:63], a[68:71], v[112:127]
  ds_read_b64_tr_b16 v[48:49], v14 offset:19456
  ds_read_b64_tr_b16 v[50:51], v14 offset:19712
  s_waitcnt lgkmcnt(8)
  v_mfma_f32_32x32x16_bf16 v[64:79], v[32:35], a[72:75], v[64:79]
  ds_read_b64_tr_b16 v[52:53], v15 offset:19456
  ds_read_b64_tr_b16 v[54:55], v15 offset:19712
  s_waitcnt lgkmcnt(8)
  v_mfma_f32_32x32x16_bf16 v[80:95], v[36:39], a[72:75], v[80:95]
  ds_read_b64_tr_b16 v[56:57], v14 offset:20480
  ds_read_b64_tr_b16 v[58:59], v14 offset:20736
  s_waitcnt lgkmcnt(8)
  v_mfma_f32_32x32x16_bf16 v[96:111], v[40:43], a[72:75], v[96:111]
  ds_read_b64_tr_b16 v[60:61], v15 offset:20480
  ds_read_b64_tr_b16 v[62:63], v15 offset:20736
  s_waitcnt lgkmcnt(8)
  v_mfma_f32_32x32x16_bf16 v[112:127], v[44:47], a[72:75], v[112:127]
  v_add_u32 v28, 24576, v12
  v_add_u32 v29, 24576, v13
  s_waitcnt vmcnt(6)
  s_barrier
  ds_read_b64_tr_b16 v[32:33], v28 offset:1024
  ds_read_b64_tr_b16 v[34:35], v28 offset:1280
  s_waitcnt lgkmcnt(8)
  v_mfma_f32_32x32x16_bf16 v[64:79], v[48:51], a[76:79], v[64:79]
  ds_read_b64_tr_b16 v[36:37], v29 offset:1024
  ds_read_b64_tr_b16 v[38:39], v29 offset:1280
  s_waitcnt lgkmcnt(8)
  v_mfma_f32_32x32x16_bf16 v[80:95], v[52:55], a[76:79], v[80:95]
  ds_read_b64_tr_b16 v[40:41], v28 offset:2048
  ds_read_b64_tr_b16 v[42:43], v28 offset:2304
  s_waitcnt lgkmcnt(8)
  v_mfma_f32_32x32x16_bf16 v[96:111], v[56:59], a[76:79], v[96:111]
  ds_read_b64_tr_b16 v[44:45], v29 offset:2048
  ds_read_b64_tr_b16 v[46:47], v29 offset:2304
  s_waitcnt lgkmcnt(8)
  v_mfma_f32_32x32x16_bf16 v[112:127], v[60:63], a[76:79], v[112:127]
  ds_read_b64_tr_b16 v[48:49], v28 offset:7168
  ds_read_b64_tr_b16 v[50:51], v28 offset:7424
  s_waitcnt lgkmcnt(8)
  v_mfma_f32_32x32x16_bf16 v[64:79], v[32:35], a[80:83], v[64:79]
  ds_read_b64_tr_b16 v[52:53], v29 offset:7168
  ds_read_b64_tr_b16 v[54:55], v29 offset:7424
  s_waitcnt lgkmcnt(8)
  v_mfma_f32_32x32x16_bf16 v[80:95], v[36:39], a[80:83], v[80:95]
  ds_read_b64_tr_b16 v[56:57], v28 offset:8192
  ds_read_b64_tr_b16 v[58:59], v28 offset:8448
  s_waitcnt lgkmcnt(8)
  v_mfma_f32_32x32x16_bf16 v[96:111], v[40:43], a[80:83], v[96:111]
  ds_read_b64_tr_b16 v[60:61], v29 offset:8192
  ds_read_b64_tr_b16 v[62:63], v29 offset:8448
  s_waitcnt lgkmcnt(8)
  v_mfma_f32_32x32x16_bf16 v[112:127], v[44:47], a[80:83], v[112:127]
  ds_read_b64_tr_b16 v[32:33], v28 offset:13312
  ds_read_b64_tr_b16 v[34:35], v28 offset:13568
  s_waitcnt lgkmcnt(8)
  v_mfma_f32_32x32x16_bf16 v[64:79], v[48:51], a[84:87], v[64:79]
  ds_read_b64_tr_b16 v[36:37], v29 offset:13312
  ds_read_b64_tr_b16 v[38:39], v29 offset:13568
  s_waitcnt lgkmcnt(8)
  v_mfma_f32_32x32x16_bf16 v[80:95], v[52:55], a[84:87], v[80:95]
  ds_read_b64_tr_b16 v[40:41], v28 offset:14336
  ds_read_b64_tr_b16 v[42:43], v28 offset:14592
  s_waitcnt lgkmcnt(8)
  v_mfma_f32_32x32x16_bf16 v[96:111], v[56:59], a[84:87], v[96:111]
  ds_read_b64_tr_b16 v[44:45], v29 offset:14336
  ds_read_b64_tr_b16 v[46:47], v29 offset:14592
  s_waitcnt lgkmcnt(8)
  v_mfma_f32_32x32x16_bf16 v[112:127], v[60:63], a[84:87], v[112:127]
  ds_read_b64_tr_b16 v[48:49], v28 offset:19456
  ds_read_b64_tr_b16 v[50:51], v28 offset:19712
  s_waitcnt lgkmcnt(8)
  v_mfma_f32_32x32x16_bf16 v[64:79], v[32:35], a[88:91], v[64:79]
  ds_read_b64_tr_b16 v[52:53], v29 offset:19456
  ds_read_b64_tr_b16 v[54:55], v29 offset:19712
  s_waitcnt lgkmcnt(8)
  v_mfma_f32_32x32x16_bf16 v[80:95], v[36:39], a[88:91], v[80:95]
  ds_read_b64_tr_b16 v[56:57], v28 offset:20480
  ds_read_b64_tr_b16 v[58:59], v28 offset:20736
  s_waitcnt lgkmcnt(8)
  v_mfma_f32_32x32x16_bf16 v[96:111], v[40:43], a[88:91], v[96:111]
  ds_read_b64_tr_b16 v[60:61], v29 offset:20480
  ds_read_b64_tr_b16 v[62:63], v29 offset:20736
  s_waitcnt lgkmcnt(8)
  v_mfma_f32_32x32x16_bf16 v[112:127], v[44:47], a[88:91], v[112:127]
  s_waitcnt vmcnt(0)
  v_add_u32 v30, 49152, v12
  v_add_u32 v31, 49152, v13
  s_waitcnt lgkmcnt(0)
  s_barrier
  ds_read_b64_tr_b16 v[32:33], v30 offset:1024
  ds_read_b64_tr_b16 v[34:35], v30 offset:1280
  v_mfma_f32_32x32x16_bf16 v[64:79], v[48:51], a[92:95], v[64:79]
  ds_read_b64_tr_b16 v[36:37], v31 offset:1024
  ds_read_b64_tr_b16 v[38:39], v31 offset:1280
  v_mfma_f32_32x32x16_bf16 v[80:95], v[52:55], a[92:95], v[80:95]
  ds_read_b64_tr_b16 v[40:41], v30 offset:7168
  ds_read_b64_tr_b16 v[42:43], v30 offset:7424
  v_mfma_f32_32x32x16_bf16 v[96:111], v[56:59], a[92:95], v[96:111]
  ds_read_b64_tr_b16 v[44:45], v31 offset:7168
  ds_read_b64_tr_b16 v[46:47], v31 offset:7424
  v_mfma_f32_32x32x16_bf16 v[112:127], v[60:63], a[92:95], v[112:127]
  ds_read_b64_tr_b16 v[48:49], v30 offset:13312
  ds_read_b64_tr_b16 v[50:51], v30 offset:13568
  s_waitcnt lgkmcnt(8)
  v_mfma_f32_32x32x16_bf16 v[64:79], v[32:35], a[96:99], v[64:79]
  ds_read_b64_tr_b16 v[52:53], v31 offset:13312
  ds_read_b64_tr_b16 v[54:55], v31 offset:13568
  s_waitcnt lgkmcnt(8)
  v_mfma_f32_32x32x16_bf16 v[80:95], v[36:39], a[96:99], v[80:95]
  ds_read_b64_tr_b16 v[56:57], v30 offset:19456
  ds_read_b64_tr_b16 v[58:59], v30 offset:19712
  s_waitcnt lgkmcnt(8)
  v_mfma_f32_32x32x16_bf16 v[64:79], v[40:43], a[100:103], v[64:79]
  ds_read_b64_tr_b16 v[60:61], v31 offset:19456
  ds_read_b64_tr_b16 v[62:63], v31 offset:19712
  s_waitcnt lgkmcnt(8)
  v_mfma_f32_32x32x16_bf16 v[80:95], v[44:47], a[100:103], v[80:95]
  v_add_u32 v14, 73728, v12
  v_add_u32 v15, 73728, v13
  ds_read_b64_tr_b16 v[32:33], v14 offset:1024
  ds_read_b64_tr_b16 v[34:35], v14 offset:1280
  s_waitcnt lgkmcnt(8)
  v_mfma_f32_32x32x16_bf16 v[64:79], v[48:51], a[104:107], v[64:79]
  ds_read_b64_tr_b16 v[36:37], v15 offset:1024
  ds_read_b64_tr_b16 v[38:39], v15 offset:1280
  s_waitcnt lgkmcnt(8)
  v_mfma_f32_32x32x16_bf16 v[80:95], v[52:55], a[104:107], v[80:95]
  ds_read_b64_tr_b16 v[40:41], v14 offset:7168
  ds_read_b64_tr_b16 v[42:43], v14 offset:7424
  s_waitcnt lgkmcnt(8)
  v_mfma_f32_32x32x16_bf16 v[64:79], v[56:59], a[108:111], v[64:79]
  ds_read_b64_tr_b16 v[44:45], v15 offset:7168
  ds_read_b64_tr_b16 v[46:47], v15 offset:7424
  s_waitcnt lgkmcnt(8)
  v_mfma_f32_32x32x16_bf16 v[80:95], v[60:63], a[108:111], v[80:95]
  ds_read_b64_tr_b16 v[48:49], v14 offset:13312
  ds_read_b64_tr_b16 v[50:51], v14 offset:13568
  s_waitcnt lgkmcnt(8)
  v_mfma_f32_32x32x16_bf16 v[64:79], v[32:35], a[112:115], v[64:79]
  ds_read_b64_tr_b16 v[52:53], v15 offset:13312
  ds_read_b64_tr_b16 v[54:55], v15 offset:13568
  s_waitcnt lgkmcnt(8)
  v_mfma_f32_32x32x16_bf16 v[80:95], v[36:39], a[112:115], v[80:95]
  ds_read_b64_tr_b16 v[56:57], v14 offset:19456
  ds_read_b64_tr_b16 v[58:59], v14 offset:19712
  s_waitcnt lgkmcnt(8)
  v_mfma_f32_32x32x16_bf16 v[64:79], v[40:43], a[116:119], v[64:79]
  ds_read_b64_tr_b16 v[60:61], v15 offset:19456
  ds_read_b64_tr_b16 v[62:63], v15 offset:19712
  s_waitcnt lgkmcnt(8)
  v_mfma_f32_32x32x16_bf16 v[80:95], v[44:47], a[116:119], v[80:95]
  ds_read_b64_tr_b16 v[32:33], v30 offset:2048
  ds_read_b64_tr_b16 v[34:35], v30 offset:2304
  s_waitcnt lgkmcnt(8)
  v_mfma_f32_32x32x16_bf16 v[64:79], v[48:51], a[120:123], v[64:79]
  ds_read_b64_tr_b16 v[36:37], v31 offset:2048
  ds_read_b64_tr_b16 v[38:39], v31 offset:2304
  s_waitcnt lgkmcnt(8)
  v_mfma_f32_32x32x16_bf16 v[80:95], v[52:55], a[120:123], v[80:95]
  ds_read_b64_tr_b16 v[40:41], v30 offset:8192
  ds_read_b64_tr_b16 v[42:43], v30 offset:8448
  s_waitcnt lgkmcnt(8)
  v_mfma_f32_32x32x16_bf16 v[64:79], v[56:59], a[124:127], v[64:79]
  ds_read_b64_tr_b16 v[44:45], v31 offset:8192
  ds_read_b64_tr_b16 v[46:47], v31 offset:8448
  s_waitcnt lgkmcnt(8)
  v_mfma_f32_32x32x16_bf16 v[80:95], v[60:63], a[124:127], v[80:95]
  ds_read_b64_tr_b16 v[48:49], v30 offset:14336
  ds_read_b64_tr_b16 v[50:51], v30 offset:14592
  s_waitcnt lgkmcnt(8)
  v_mfma_f32_32x32x16_bf16 v[96:111], v[32:35], a[96:99], v[96:111]
  ds_read_b64_tr_b16 v[52:53], v31 offset:14336
  ds_read_b64_tr_b16 v[54:55], v31 offset:14592
  s_waitcnt lgkmcnt(8)
  v_mfma_f32_32x32x16_bf16 v[112:127], v[36:39], a[96:99], v[112:127]
  ds_read_b64_tr_b16 v[56:57], v30 offset:20480
  ds_read_b64_tr_b16 v[58:59], v30 offset:20736
  v_mul_f32 v72, v64, v72
  v_mul_f32 v73, v65, v73
  v_mul_f32 v74, v66, v74
  v_mul_f32 v75, v67, v75
  v_mul_f32 v76, v68, v76
  v_mul_f32 v77, v69, v77
  s_waitcnt lgkmcnt(8)
  v_mfma_f32_32x32x16_bf16 v[96:111], v[40:43], a[100:103], v[96:111]
  ds_read_b64_tr_b16 v[60:61], v31 offset:20480
  ds_read_b64_tr_b16 v[62:63], v31 offset:20736
  v_mul_f32 v78, v70, v78
  v_mul_f32 v79, v71, v79
  v_mul_f32 v64, s80, v64
  v_mul_f32 v65, s80, v65
  v_mul_f32 v66, s80, v66
  v_mul_f32 v67, s80, v67
  s_waitcnt lgkmcnt(8)
  v_mfma_f32_32x32x16_bf16 v[112:127], v[44:47], a[100:103], v[112:127]
  ds_read_b64_tr_b16 v[32:33], v14 offset:2048
  ds_read_b64_tr_b16 v[34:35], v14 offset:2304
  v_mul_f32 v68, s80, v68
  v_mul_f32 v69, s80, v69
  v_mul_f32 v70, s80, v70
  v_mul_f32 v71, s80, v71
  v_exp_f32 v64, v64
  v_exp_f32 v65, v65
  s_waitcnt lgkmcnt(8)
  v_mfma_f32_32x32x16_bf16 v[96:111], v[48:51], a[104:107], v[96:111]
  ds_read_b64_tr_b16 v[36:37], v15 offset:2048
  ds_read_b64_tr_b16 v[38:39], v15 offset:2304
  v_exp_f32 v66, v66
  v_exp_f32 v67, v67
  v_exp_f32 v68, v68
  v_exp_f32 v69, v69
  v_exp_f32 v70, v70
  v_exp_f32 v71, v71
  s_waitcnt lgkmcnt(8)
  v_mfma_f32_32x32x16_bf16 v[112:127], v[52:55], a[104:107], v[112:127]
  ds_read_b64_tr_b16 v[40:41], v14 offset:8192
  ds_read_b64_tr_b16 v[42:43], v14 offset:8448
  v_add_f32 v64, 1.0, v64
  v_add_f32 v65, 1.0, v65
  v_add_f32 v66, 1.0, v66
  v_add_f32 v67, 1.0, v67
  v_add_f32 v68, 1.0, v68
  v_add_f32 v69, 1.0, v69
  s_waitcnt lgkmcnt(8)
  v_mfma_f32_32x32x16_bf16 v[96:111], v[56:59], a[108:111], v[96:111]
  ds_read_b64_tr_b16 v[44:45], v15 offset:8192
  ds_read_b64_tr_b16 v[46:47], v15 offset:8448
  v_add_f32 v70, 1.0, v70
  v_add_f32 v71, 1.0, v71
  v_rcp_f32 v64, v64
  v_rcp_f32 v65, v65
  v_rcp_f32 v66, v66
  v_rcp_f32 v67, v67
  s_waitcnt lgkmcnt(8)
  v_mfma_f32_32x32x16_bf16 v[112:127], v[60:63], a[108:111], v[112:127]
  ds_read_b64_tr_b16 v[48:49], v14 offset:14336
  ds_read_b64_tr_b16 v[50:51], v14 offset:14592
  v_rcp_f32 v68, v68
  v_rcp_f32 v69, v69
  v_rcp_f32 v70, v70
  v_rcp_f32 v71, v71
  v_mul_f32 v72, v72, v64
  v_mul_f32 v73, v73, v65
  s_waitcnt lgkmcnt(8)
  v_mfma_f32_32x32x16_bf16 v[96:111], v[32:35], a[112:115], v[96:111]
  ds_read_b64_tr_b16 v[52:53], v15 offset:14336
  ds_read_b64_tr_b16 v[54:55], v15 offset:14592
  v_mul_f32 v74, v74, v66
  v_mul_f32 v75, v75, v67
  v_mul_f32 v76, v76, v68
  v_mul_f32 v77, v77, v69
  v_mul_f32 v78, v78, v70
  v_mul_f32 v79, v79, v71
  s_waitcnt lgkmcnt(8)
  v_mfma_f32_32x32x16_bf16 v[112:127], v[36:39], a[112:115], v[112:127]
  ds_read_b64_tr_b16 v[56:57], v14 offset:20480
  ds_read_b64_tr_b16 v[58:59], v14 offset:20736
  v_cvt_pk_bf16_f32 v64, v72, v73
  v_cvt_pk_bf16_f32 v65, v74, v75
  v_cvt_pk_bf16_f32 v66, v76, v77
  v_cvt_pk_bf16_f32 v67, v78, v79
  buffer_store_dwordx4 v[64:67], v6, s[64:67], s82 offen offset:0 sc0 sc1
  v_mul_f32 v88, v80, v88
  s_waitcnt lgkmcnt(8)
  v_mfma_f32_32x32x16_bf16 v[96:111], v[40:43], a[116:119], v[96:111]
  ds_read_b64_tr_b16 v[60:61], v15 offset:20480
  ds_read_b64_tr_b16 v[62:63], v15 offset:20736
  v_mul_f32 v89, v81, v89
  v_mul_f32 v90, v82, v90
  v_mul_f32 v91, v83, v91
  v_mul_f32 v92, v84, v92
  v_mul_f32 v93, v85, v93
  v_mul_f32 v94, v86, v94
  s_waitcnt lgkmcnt(8)
  v_mfma_f32_32x32x16_bf16 v[112:127], v[44:47], a[116:119], v[112:127]
  v_mul_f32 v95, v87, v95
  v_mul_f32 v80, s80, v80
  v_mul_f32 v81, s80, v81
  v_mul_f32 v82, s80, v82
  v_mul_f32 v83, s80, v83
  v_mul_f32 v84, s80, v84
  s_waitcnt lgkmcnt(6)
  v_mfma_f32_32x32x16_bf16 v[96:111], v[48:51], a[120:123], v[96:111]
  v_mul_f32 v85, s80, v85
  v_mul_f32 v86, s80, v86
  v_mul_f32 v87, s80, v87
  v_exp_f32 v80, v80
  v_exp_f32 v81, v81
  v_exp_f32 v82, v82
  s_waitcnt lgkmcnt(4)
  v_mfma_f32_32x32x16_bf16 v[112:127], v[52:55], a[120:123], v[112:127]
  v_exp_f32 v83, v83
  v_exp_f32 v84, v84
  v_exp_f32 v85, v85
  v_exp_f32 v86, v86
  v_exp_f32 v87, v87
  v_add_f32 v80, 1.0, v80
  s_waitcnt lgkmcnt(2)
  v_mfma_f32_32x32x16_bf16 v[96:111], v[56:59], a[124:127], v[96:111]
  v_add_f32 v81, 1.0, v81
  v_add_f32 v82, 1.0, v82
  v_add_f32 v83, 1.0, v83
  v_add_f32 v84, 1.0, v84
  v_add_f32 v85, 1.0, v85
  v_add_f32 v86, 1.0, v86
  s_waitcnt lgkmcnt(0)
  v_mfma_f32_32x32x16_bf16 v[112:127], v[60:63], a[124:127], v[112:127]
  v_add_f32 v87, 1.0, v87
  v_rcp_f32 v80, v80
  v_rcp_f32 v81, v81
  v_rcp_f32 v82, v82
  v_rcp_f32 v83, v83
  v_rcp_f32 v84, v84
  v_rcp_f32 v85, v85
  v_rcp_f32 v86, v86
  v_rcp_f32 v87, v87
  v_mul_f32 v88, v88, v80
  v_mul_f32 v89, v89, v81
  v_mul_f32 v90, v90, v82
  v_mul_f32 v91, v91, v83
  v_mul_f32 v92, v92, v84
  v_mul_f32 v93, v93, v85
  v_mul_f32 v94, v94, v86
  v_mul_f32 v95, v95, v87
  v_cvt_pk_bf16_f32 v80, v88, v89
  v_cvt_pk_bf16_f32 v81, v90, v91
  v_cvt_pk_bf16_f32 v82, v92, v93
  v_cvt_pk_bf16_f32 v83, v94, v95
  buffer_store_dwordx4 v[80:83], v6, s[64:67], s82 offen offset:1024 sc0 sc1
  v_pk_mul_f32 v[104:105], v[96:97], v[104:105]
  v_pk_mul_f32 v[106:107], v[98:99], v[106:107]
  v_pk_mul_f32 v[108:109], v[100:101], v[108:109]
  v_pk_mul_f32 v[110:111], v[102:103], v[110:111]
  v_pk_mul_f32 v[96:97], v[96:97], s[80:81] op_sel_hi:[1,0]
  v_pk_mul_f32 v[98:99], v[98:99], s[80:81] op_sel_hi:[1,0]
  v_pk_mul_f32 v[100:101], v[100:101], s[80:81] op_sel_hi:[1,0]
  v_pk_mul_f32 v[102:103], v[102:103], s[80:81] op_sel_hi:[1,0]
  v_exp_f32 v96, v96
  v_exp_f32 v97, v97
  v_exp_f32 v98, v98
  v_exp_f32 v99, v99
  v_exp_f32 v100, v100
  v_exp_f32 v101, v101
  v_exp_f32 v102, v102
  v_exp_f32 v103, v103
  v_pk_add_f32 v[96:97], v[96:97], 1.0 op_sel_hi:[1,0]
  v_pk_add_f32 v[98:99], v[98:99], 1.0 op_sel_hi:[1,0]
  v_pk_add_f32 v[100:101], v[100:101], 1.0 op_sel_hi:[1,0]
  v_pk_add_f32 v[102:103], v[102:103], 1.0 op_sel_hi:[1,0]
  v_rcp_f32 v96, v96
  v_rcp_f32 v97, v97
  v_rcp_f32 v98, v98
  v_rcp_f32 v99, v99
  v_rcp_f32 v100, v100
  v_rcp_f32 v101, v101
  v_rcp_f32 v102, v102
  v_rcp_f32 v103, v103
  v_pk_mul_f32 v[104:105], v[104:105], v[96:97]
  v_pk_mul_f32 v[106:107], v[106:107], v[98:99]
  v_pk_mul_f32 v[108:109], v[108:109], v[100:101]
  v_pk_mul_f32 v[110:111], v[110:111], v[102:103]
  v_cvt_pk_bf16_f32 v96, v104, v105
  v_cvt_pk_bf16_f32 v97, v106, v107
  v_cvt_pk_bf16_f32 v98, v108, v109
  v_cvt_pk_bf16_f32 v99, v110, v111
  v_pk_mul_f32 v[120:121], v[112:113], v[120:121]
  v_pk_mul_f32 v[122:123], v[114:115], v[122:123]
  v_pk_mul_f32 v[124:125], v[116:117], v[124:125]
  v_pk_mul_f32 v[126:127], v[118:119], v[126:127]
  v_pk_mul_f32 v[112:113], v[112:113], s[80:81] op_sel_hi:[1,0]
  v_pk_mul_f32 v[114:115], v[114:115], s[80:81] op_sel_hi:[1,0]
  v_pk_mul_f32 v[116:117], v[116:117], s[80:81] op_sel_hi:[1,0]
  v_pk_mul_f32 v[118:119], v[118:119], s[80:81] op_sel_hi:[1,0]
  v_exp_f32 v112, v112
  v_exp_f32 v113, v113
  v_exp_f32 v114, v114
  v_exp_f32 v115, v115
  v_exp_f32 v116, v116
  v_exp_f32 v117, v117
  v_exp_f32 v118, v118
  v_exp_f32 v119, v119
  v_pk_add_f32 v[112:113], v[112:113], 1.0 op_sel_hi:[1,0]
  v_pk_add_f32 v[114:115], v[114:115], 1.0 op_sel_hi:[1,0]
  v_pk_add_f32 v[116:117], v[116:117], 1.0 op_sel_hi:[1,0]
  v_pk_add_f32 v[118:119], v[118:119], 1.0 op_sel_hi:[1,0]
  v_rcp_f32 v112, v112
  v_rcp_f32 v113, v113
  v_rcp_f32 v114, v114
  v_rcp_f32 v115, v115
  v_rcp_f32 v116, v116
  v_rcp_f32 v117, v117
  v_rcp_f32 v118, v118
  v_rcp_f32 v119, v119
  v_pk_mul_f32 v[120:121], v[120:121], v[112:113]
  v_pk_mul_f32 v[122:123], v[122:123], v[114:115]
  v_pk_mul_f32 v[124:125], v[124:125], v[116:117]
  v_pk_mul_f32 v[126:127], v[126:127], v[118:119]
  v_cvt_pk_bf16_f32 v112, v120, v121
  v_cvt_pk_bf16_f32 v113, v122, v123
  v_cvt_pk_bf16_f32 v114, v124, v125
  v_cvt_pk_bf16_f32 v115, v126, v127
  v_xor_b32 v28, 0x200, v22
  s_barrier
  ds_read_u16 v48, v21 offset:0
  ds_read_u16 v49, v21 offset:128
  ds_read_u16 v50, v21 offset:256
  ds_read_u16 v51, v21 offset:384
  ds_read_u16 v52, v21 offset:512
  ds_read_u16 v53, v21 offset:640
  ds_read_u16 v54, v21 offset:768
  ds_read_u16 v55, v21 offset:896
  ds_read_u16 v56, v21 offset:1024
  ds_read_u16 v57, v21 offset:1152
  ds_read_u16 v58, v21 offset:1280
  ds_read_u16 v59, v21 offset:1408
  ds_read_u16 v60, v21 offset:1536
  ds_read_u16 v61, v21 offset:1664
  ds_read_u16 v62, v21 offset:1792
  ds_read_u16 v63, v21 offset:1920
  ds_read_u16 v16, v23
  buffer_store_dwordx4 v[96:99], v6, s[64:67], s87 offen offset:2048 sc0 sc1
  v_add_u32 v24, 0, v18
  v_xor_b32 v25, 32, v24
  v_xor_b32 v26, 64, v24
  v_xor_b32 v27, 0x60, v24
  s_barrier
  s_waitcnt lgkmcnt(13)
  ds_read_b64_tr_b16 a[16:17], v11 offset:8192
  ds_read_b64_tr_b16 a[18:19], v10 offset:8192
  ds_read_b128 a[80:83], v24
  s_waitcnt lgkmcnt(12)
  ds_read_b64_tr_b16 a[20:21], v11 offset:8704
  ds_read_b64_tr_b16 a[22:23], v10 offset:8704
  ds_read_b128 a[84:87], v25
  s_waitcnt lgkmcnt(11)
  ds_read_b64_tr_b16 a[24:25], v11 offset:10240
  ds_read_b64_tr_b16 a[26:27], v10 offset:10240
  ds_read_b128 a[88:91], v26
  s_waitcnt lgkmcnt(9)
  ds_read_b64_tr_b16 a[28:29], v11 offset:10752
  ds_read_b64_tr_b16 a[30:31], v10 offset:10752
  ds_read_b128 a[92:95], v27
  buffer_store_dwordx4 v[112:115], v6, s[64:67], s87 offen offset:3072 sc0 sc1
  v_lshlrev_b32 v16, 16, v16
  v_lshlrev_b32 v48, 16, v48
  v_lshlrev_b32 v49, 16, v49
  v_mul_f32 v48, v48, v16
  v_mul_f32 v49, v49, v16
  v_cvt_pk_bf16_f32 v48, v48, v49
  v_and_b32 v49, 0xffff0000, v48
  v_lshlrev_b32 v48, 16, v48
  v_lshlrev_b32 v50, 16, v50
  v_lshlrev_b32 v51, 16, v51
  v_mul_f32 v50, v50, v16
  v_mul_f32 v51, v51, v16
  v_cvt_pk_bf16_f32 v50, v50, v51
  v_and_b32 v51, 0xffff0000, v50
  v_lshlrev_b32 v50, 16, v50
  v_add_u32 v24, 8192, v18
  v_xor_b32 v25, 32, v24
  v_xor_b32 v26, 64, v24
  v_xor_b32 v27, 0x60, v24
  s_barrier
  s_waitcnt lgkmcnt(9)
  v_mfma_f32_32x32x16_bf16 v[32:47], a[16:19], a[80:83], 0
  ds_read_b64_tr_b16 a[0:1], v11 offset:16384
  ds_read_b64_tr_b16 a[2:3], v10 offset:16384
  ds_read_b128 a[96:99], v24
  s_waitcnt lgkmcnt(9)
  v_mfma_f32_32x32x16_bf16 v[32:47], a[20:23], a[84:87], v[32:47]
  ds_read_b64_tr_b16 a[4:5], v11 offset:16896
  ds_read_b64_tr_b16 a[6:7], v10 offset:16896
  ds_read_b128 a[100:103], v25
  s_waitcnt lgkmcnt(9)
  v_mfma_f32_32x32x16_bf16 v[32:47], a[24:27], a[88:91], v[32:47]
  ds_read_b64_tr_b16 a[8:9], v11 offset:18432
  ds_read_b64_tr_b16 a[10:11], v10 offset:18432
  ds_read_b128 a[104:107], v26
  s_waitcnt lgkmcnt(9)
  v_mfma_f32_32x32x16_bf16 v[32:47], a[28:31], a[92:95], v[32:47]
  ds_read_b64_tr_b16 a[12:13], v11 offset:18944
  ds_read_b64_tr_b16 a[14:15], v10 offset:18944
  ds_read_b128 a[108:111], v27
  v_lshlrev_b32 v52, 16, v52
  v_lshlrev_b32 v53, 16, v53
  v_mul_f32 v52, v52, v16
  v_mul_f32 v53, v53, v16
  v_cvt_pk_bf16_f32 v52, v52, v53
  v_and_b32 v53, 0xffff0000, v52
  v_lshlrev_b32 v52, 16, v52
  v_lshlrev_b32 v54, 16, v54
  v_lshlrev_b32 v55, 16, v55
  v_mul_f32 v54, v54, v16
  v_mul_f32 v55, v55, v16
  v_cvt_pk_bf16_f32 v54, v54, v55
  v_and_b32 v55, 0xffff0000, v54
  v_lshlrev_b32 v54, 16, v54
  v_add_u32 v24, 16384, v18
  v_xor_b32 v25, 32, v24
  v_xor_b32 v26, 64, v24
  v_xor_b32 v27, 0x60, v24
  s_barrier
  s_waitcnt lgkmcnt(9)
  v_mfma_f32_32x32x16_bf16 v[32:47], a[0:3], a[96:99], v[32:47]
  ds_read_b64_tr_b16 a[16:17], v11 offset:24576
  ds_read_b64_tr_b16 a[18:19], v10 offset:24576
  ds_read_b128 a[32:35], v24
  s_waitcnt lgkmcnt(9)
  v_mfma_f32_32x32x16_bf16 v[32:47], a[4:7], a[100:103], v[32:47]
  ds_read_b64_tr_b16 a[20:21], v11 offset:25088
  ds_read_b64_tr_b16 a[22:23], v10 offset:25088
  ds_read_b128 a[36:39], v25
  s_waitcnt lgkmcnt(9)
  v_mfma_f32_32x32x16_bf16 v[32:47], a[8:11], a[104:107], v[32:47]
  ds_read_b64_tr_b16 a[24:25], v11 offset:26624
  ds_read_b64_tr_b16 a[26:27], v10 offset:26624
  ds_read_b128 a[40:43], v26
  s_waitcnt lgkmcnt(9)
  v_mfma_f32_32x32x16_bf16 v[32:47], a[12:15], a[108:111], v[32:47]
  ds_read_b64_tr_b16 a[28:29], v11 offset:27136
  ds_read_b64_tr_b16 a[30:31], v10 offset:27136
  ds_read_b128 a[44:47], v27
  v_lshlrev_b32 v56, 16, v56
  v_lshlrev_b32 v57, 16, v57
  v_mul_f32 v56, v56, v16
  v_mul_f32 v57, v57, v16
  v_cvt_pk_bf16_f32 v56, v56, v57
  v_and_b32 v57, 0xffff0000, v56
  v_lshlrev_b32 v56, 16, v56
  v_lshlrev_b32 v58, 16, v58
  v_lshlrev_b32 v59, 16, v59
  v_mul_f32 v58, v58, v16
  v_mul_f32 v59, v59, v16
  v_cvt_pk_bf16_f32 v58, v58, v59
  v_and_b32 v59, 0xffff0000, v58
  v_lshlrev_b32 v58, 16, v58
  s_barrier
  s_waitcnt lgkmcnt(9)
  v_mfma_f32_32x32x16_bf16 v[32:47], a[16:19], a[32:35], v[32:47]
  ds_read_b64_tr_b16 a[0:1], v11 offset:32768
  ds_read_b64_tr_b16 a[2:3], v10 offset:32768
  s_waitcnt lgkmcnt(8)
  v_mfma_f32_32x32x16_bf16 v[32:47], a[20:23], a[36:39], v[32:47]
  ds_read_b64_tr_b16 a[4:5], v11 offset:33280
  ds_read_b64_tr_b16 a[6:7], v10 offset:33280
  s_waitcnt lgkmcnt(7)
  v_mfma_f32_32x32x16_bf16 v[32:47], a[24:27], a[40:43], v[32:47]
  ds_read_b64_tr_b16 a[8:9], v11 offset:34816
  ds_read_b64_tr_b16 a[10:11], v10 offset:34816
  s_waitcnt lgkmcnt(6)
  v_mfma_f32_32x32x16_bf16 v[32:47], a[28:31], a[44:47], v[32:47]
  ds_read_b64_tr_b16 a[12:13], v11 offset:35328
  ds_read_b64_tr_b16 a[14:15], v10 offset:35328
  v_lshlrev_b32 v60, 16, v60
  v_lshlrev_b32 v61, 16, v61
  v_mul_f32 v60, v60, v16
  v_mul_f32 v61, v61, v16
  v_cvt_pk_bf16_f32 v60, v60, v61
  v_and_b32 v61, 0xffff0000, v60
  v_lshlrev_b32 v60, 16, v60
  v_lshlrev_b32 v62, 16, v62
  v_lshlrev_b32 v63, 16, v63
  v_mul_f32 v62, v62, v16
  v_mul_f32 v63, v63, v16
  v_cvt_pk_bf16_f32 v62, v62, v63
  v_and_b32 v63, 0xffff0000, v62
  v_lshlrev_b32 v62, 16, v62
  v_add_u32 v24, 24576, v18
  v_xor_b32 v25, 32, v24
  v_xor_b32 v26, 64, v24
  v_xor_b32 v27, 0x60, v24
  s_waitcnt vmcnt(0)
  s_barrier
  s_waitcnt lgkmcnt(6)
  v_mfma_f32_32x32x16_bf16 v[48:63], a[0:3], a[32:35], v[48:63]
  ds_read_b64_tr_b16 a[16:17], v11 offset:40960
  ds_read_b64_tr_b16 a[18:19], v10 offset:40960
  ds_read_b128 a[64:67], v24
  s_waitcnt lgkmcnt(7)
  v_mfma_f32_32x32x16_bf16 v[48:63], a[4:7], a[36:39], v[48:63]
  ds_read_b64_tr_b16 a[20:21], v11 offset:41472
  ds_read_b64_tr_b16 a[22:23], v10 offset:41472
  ds_read_b128 a[68:71], v25
  s_waitcnt lgkmcnt(8)
  v_mfma_f32_32x32x16_bf16 v[48:63], a[8:11], a[40:43], v[48:63]
  ds_read_b64_tr_b16 a[24:25], v11 offset:43008
  ds_read_b64_tr_b16 a[26:27], v10 offset:43008
  ds_read_b128 a[72:75], v26
  s_waitcnt lgkmcnt(9)
  v_mfma_f32_32x32x16_bf16 v[48:63], a[12:15], a[44:47], v[48:63]
  ds_read_b64_tr_b16 a[28:29], v11 offset:43520
  ds_read_b64_tr_b16 a[30:31], v10 offset:43520
  ds_read_b128 a[76:79], v27
  s_barrier
  s_waitcnt lgkmcnt(9)
  v_mfma_f32_32x32x16_bf16 v[32:47], a[16:19], a[64:67], v[32:47]
  ds_read_b64_tr_b16 a[0:1], v11 offset:49152
  ds_read_b64_tr_b16 a[2:3], v10 offset:49152
  s_waitcnt lgkmcnt(8)
  v_mfma_f32_32x32x16_bf16 v[32:47], a[20:23], a[68:71], v[32:47]
  ds_read_b64_tr_b16 a[4:5], v11 offset:49664
  ds_read_b64_tr_b16 a[6:7], v10 offset:49664
  s_waitcnt lgkmcnt(7)
  v_mfma_f32_32x32x16_bf16 v[32:47], a[24:27], a[72:75], v[32:47]
  ds_read_b64_tr_b16 a[8:9], v11 offset:51200
  ds_read_b64_tr_b16 a[10:11], v10 offset:51200
  s_waitcnt lgkmcnt(6)
  v_mfma_f32_32x32x16_bf16 v[32:47], a[28:31], a[76:79], v[32:47]
  ds_read_b64_tr_b16 a[12:13], v11 offset:51712
  ds_read_b64_tr_b16 a[14:15], v10 offset:51712
  v_add_u32 v24, 32768, v18
  v_xor_b32 v25, 32, v24
  v_xor_b32 v26, 64, v24
  v_xor_b32 v27, 0x60, v24
  s_barrier
  s_waitcnt lgkmcnt(6)
  v_mfma_f32_32x32x16_bf16 v[48:63], a[0:3], a[64:67], v[48:63]
  ds_read_b64_tr_b16 a[16:17], v11 offset:0
  ds_read_b64_tr_b16 a[18:19], v10 offset:0
  ds_read_b128 a[48:51], v24
  s_waitcnt lgkmcnt(7)
  v_mfma_f32_32x32x16_bf16 v[48:63], a[4:7], a[68:71], v[48:63]
  ds_read_b64_tr_b16 a[20:21], v11 offset:512
  ds_read_b64_tr_b16 a[22:23], v10 offset:512
  ds_read_b128 a[52:55], v25
  s_waitcnt lgkmcnt(8)
  v_mfma_f32_32x32x16_bf16 v[48:63], a[8:11], a[72:75], v[48:63]
  ds_read_b64_tr_b16 a[24:25], v11 offset:2048
  ds_read_b64_tr_b16 a[26:27], v10 offset:2048
  ds_read_b128 a[56:59], v26
  s_waitcnt lgkmcnt(9)
  v_mfma_f32_32x32x16_bf16 v[48:63], a[12:15], a[76:79], v[48:63]
  ds_read_b64_tr_b16 a[28:29], v11 offset:2560
  ds_read_b64_tr_b16 a[30:31], v10 offset:2560
  ds_read_b128 a[60:63], v27
  s_barrier
  s_waitcnt lgkmcnt(9)
  v_mfma_f32_32x32x16_bf16 v[32:47], a[16:19], a[48:51], v[32:47]
  ds_read_b64_tr_b16 a[0:1], v11 offset:8192
  ds_read_b64_tr_b16 a[2:3], v10 offset:8192
  s_waitcnt lgkmcnt(8)
  v_mfma_f32_32x32x16_bf16 v[32:47], a[20:23], a[52:55], v[32:47]
  ds_read_b64_tr_b16 a[4:5], v11 offset:8704
  ds_read_b64_tr_b16 a[6:7], v10 offset:8704
  s_waitcnt lgkmcnt(7)
  v_mfma_f32_32x32x16_bf16 v[32:47], a[24:27], a[56:59], v[32:47]
  ds_read_b64_tr_b16 a[8:9], v11 offset:10240
  ds_read_b64_tr_b16 a[10:11], v10 offset:10240
  s_waitcnt lgkmcnt(6)
  v_mfma_f32_32x32x16_bf16 v[32:47], a[28:31], a[60:63], v[32:47]
  ds_read_b64_tr_b16 a[12:13], v11 offset:10752
  ds_read_b64_tr_b16 a[14:15], v10 offset:10752
  ds_read_b128 v[96:99], v28 offset:0
  ds_read_b128 v[100:103], v28 offset:16
  ds_read_b128 v[104:107], v28 offset:32
  ds_read_b128 v[108:111], v28 offset:48
  ds_read_b128 v[112:115], v28 offset:64
  ds_read_b128 v[116:119], v28 offset:80
  ds_read_b128 v[120:123], v28 offset:96
  ds_read_b128 v[124:127], v28 offset:112
  v_add_u32 v24, 40960, v18
  v_xor_b32 v25, 32, v24
  v_xor_b32 v26, 64, v24
  v_xor_b32 v27, 0x60, v24
  s_barrier
  s_waitcnt lgkmcnt(14)
  v_mfma_f32_32x32x16_bf16 v[48:63], a[0:3], a[48:51], v[48:63]
  ds_read_b64_tr_b16 a[16:17], v11 offset:16384
  ds_read_b64_tr_b16 a[18:19], v10 offset:16384
  ds_read_b128 a[32:35], v24
  s_waitcnt lgkmcnt(15)
  v_mfma_f32_32x32x16_bf16 v[48:63], a[4:7], a[52:55], v[48:63]
  ds_read_b64_tr_b16 a[20:21], v11 offset:16896
  ds_read_b64_tr_b16 a[22:23], v10 offset:16896
  ds_read_b128 a[36:39], v25
  s_waitcnt lgkmcnt(15)
  v_mfma_f32_32x32x16_bf16 v[48:63], a[8:11], a[56:59], v[48:63]
  ds_read_b64_tr_b16 a[24:25], v11 offset:18432
  ds_read_b64_tr_b16 a[26:27], v10 offset:18432
  ds_read_b128 a[40:43], v26
  s_waitcnt lgkmcnt(15)
  v_mfma_f32_32x32x16_bf16 v[48:63], a[12:15], a[60:63], v[48:63]
  ds_read_b64_tr_b16 a[28:29], v11 offset:18944
  ds_read_b64_tr_b16 a[30:31], v10 offset:18944
  ds_read_b128 a[44:47], v27
  v_mov_b32 v81, s86
  v_mov_b32 v83, s86
  v_mov_b32 v85, s86
  v_mov_b32 v87, s86
  v_mov_b32 v89, s86
  v_mov_b32 v91, s86
  v_mov_b32 v93, s86
  v_mov_b32 v95, s86
  s_barrier
  s_waitcnt lgkmcnt(9)
  v_mfma_f32_32x32x16_bf16 v[32:47], a[16:19], a[32:35], v[32:47]
  ds_read_b64_tr_b16 a[0:1], v11 offset:24576
  ds_read_b64_tr_b16 a[2:3], v10 offset:24576
  s_waitcnt lgkmcnt(8)
  v_mfma_f32_32x32x16_bf16 v[32:47], a[20:23], a[36:39], v[32:47]
  ds_read_b64_tr_b16 a[4:5], v11 offset:25088
  ds_read_b64_tr_b16 a[6:7], v10 offset:25088
  s_waitcnt lgkmcnt(7)
  v_mfma_f32_32x32x16_bf16 v[32:47], a[24:27], a[40:43], v[32:47]
  ds_read_b64_tr_b16 a[8:9], v11 offset:26624
  ds_read_b64_tr_b16 a[10:11], v10 offset:26624
  s_waitcnt lgkmcnt(6)
  v_mfma_f32_32x32x16_bf16 v[32:47], a[28:31], a[44:47], v[32:47]
  ds_read_b64_tr_b16 a[12:13], v11 offset:27136
  ds_read_b64_tr_b16 a[14:15], v10 offset:27136
  v_add_u32 v24, 49152, v18
  v_xor_b32 v25, 32, v24
  v_xor_b32 v26, 64, v24
  v_xor_b32 v27, 0x60, v24
  s_barrier
  s_waitcnt lgkmcnt(6)
  v_mfma_f32_32x32x16_bf16 v[48:63], a[0:3], a[32:35], v[48:63]
  ds_read_b64_tr_b16 a[16:17], v11 offset:32768
  ds_read_b64_tr_b16 a[18:19], v10 offset:32768
  ds_read_b128 a[64:67], v24
  s_waitcnt lgkmcnt(7)
  v_mfma_f32_32x32x16_bf16 v[48:63], a[4:7], a[36:39], v[48:63]
  ds_read_b64_tr_b16 a[20:21], v11 offset:33280
  ds_read_b64_tr_b16 a[22:23], v10 offset:33280
  ds_read_b128 a[68:71], v25
  s_waitcnt lgkmcnt(8)
  v_mfma_f32_32x32x16_bf16 v[48:63], a[8:11], a[40:43], v[48:63]
  ds_read_b64_tr_b16 a[24:25], v11 offset:34816
  ds_read_b64_tr_b16 a[26:27], v10 offset:34816
  ds_read_b128 a[72:75], v26
  s_waitcnt lgkmcnt(9)
  v_mfma_f32_32x32x16_bf16 v[48:63], a[12:15], a[44:47], v[48:63]
  ds_read_b64_tr_b16 a[28:29], v11 offset:35328
  ds_read_b64_tr_b16 a[30:31], v10 offset:35328
  ds_read_b128 a[76:79], v27
  s_barrier
  s_waitcnt lgkmcnt(9)
  v_mfma_f32_32x32x16_bf16 v[32:47], a[16:19], a[64:67], v[32:47]
  ds_read_b64_tr_b16 a[0:1], v11 offset:40960
  ds_read_b64_tr_b16 a[2:3], v10 offset:40960
  s_waitcnt lgkmcnt(8)
  v_mfma_f32_32x32x16_bf16 v[32:47], a[20:23], a[68:71], v[32:47]
  ds_read_b64_tr_b16 a[4:5], v11 offset:41472
  ds_read_b64_tr_b16 a[6:7], v10 offset:41472
  s_waitcnt lgkmcnt(7)
  v_mfma_f32_32x32x16_bf16 v[32:47], a[24:27], a[72:75], v[32:47]
  ds_read_b64_tr_b16 a[8:9], v11 offset:43008
  ds_read_b64_tr_b16 a[10:11], v10 offset:43008
  s_waitcnt lgkmcnt(6)
  v_mfma_f32_32x32x16_bf16 v[32:47], a[28:31], a[76:79], v[32:47]
  ds_read_b64_tr_b16 a[12:13], v11 offset:43520
  ds_read_b64_tr_b16 a[14:15], v10 offset:43520
  v_add_u32 v24, 57344, v18
  v_xor_b32 v25, 32, v24
  v_xor_b32 v26, 64, v24
  v_xor_b32 v27, 0x60, v24
  s_barrier
  s_waitcnt lgkmcnt(6)
  v_mfma_f32_32x32x16_bf16 v[48:63], a[0:3], a[64:67], v[48:63]
  ds_read_b64_tr_b16 a[16:17], v11 offset:49152
  ds_read_b64_tr_b16 a[18:19], v10 offset:49152
  ds_read_b128 a[48:51], v24
  s_waitcnt lgkmcnt(7)
  v_mfma_f32_32x32x16_bf16 v[48:63], a[4:7], a[68:71], v[48:63]
  ds_read_b64_tr_b16 a[20:21], v11 offset:49664
  ds_read_b64_tr_b16 a[22:23], v10 offset:49664
  ds_read_b128 a[52:55], v25
  s_waitcnt lgkmcnt(8)
  v_mfma_f32_32x32x16_bf16 v[48:63], a[8:11], a[72:75], v[48:63]
  ds_read_b64_tr_b16 a[24:25], v11 offset:51200
  ds_read_b64_tr_b16 a[26:27], v10 offset:51200
  ds_read_b128 a[56:59], v26
  s_waitcnt lgkmcnt(9)
  v_mfma_f32_32x32x16_bf16 v[48:63], a[12:15], a[76:79], v[48:63]
  ds_read_b64_tr_b16 a[28:29], v11 offset:51712
  ds_read_b64_tr_b16 a[30:31], v10 offset:51712
  ds_read_b128 a[60:63], v27
  s_barrier
  s_waitcnt lgkmcnt(9)
  v_mfma_f32_32x32x16_bf16 v[32:47], a[16:19], a[48:51], v[32:47]
  ds_read_b64_tr_b16 a[0:1], v11 offset:0
  ds_read_b64_tr_b16 a[2:3], v10 offset:0
  s_waitcnt lgkmcnt(8)
  v_mfma_f32_32x32x16_bf16 v[32:47], a[20:23], a[52:55], v[32:47]
  ds_read_b64_tr_b16 a[4:5], v11 offset:512
  ds_read_b64_tr_b16 a[6:7], v10 offset:512
  s_waitcnt lgkmcnt(7)
  v_mfma_f32_32x32x16_bf16 v[32:47], a[24:27], a[56:59], v[32:47]
  ds_read_b64_tr_b16 a[8:9], v11 offset:2048
  ds_read_b64_tr_b16 a[10:11], v10 offset:2048
  s_waitcnt lgkmcnt(6)
  v_mfma_f32_32x32x16_bf16 v[32:47], a[28:31], a[60:63], v[32:47]
  ds_read_b64_tr_b16 a[12:13], v11 offset:2560
  ds_read_b64_tr_b16 a[14:15], v10 offset:2560
  v_add_u32 v24, 65536, v19
  s_barrier
  s_waitcnt lgkmcnt(6)
  v_mfma_f32_32x32x16_bf16 v[48:63], a[0:3], a[48:51], v[48:63]
  ds_read_b128 a[16:19], v17 offset:8192
  ds_read_b64_tr_b16 a[32:33], v24 offset:0
  ds_read_b64_tr_b16 a[34:35], v24 offset:1024
  s_waitcnt lgkmcnt(7)
  v_mfma_f32_32x32x16_bf16 v[48:63], a[4:7], a[52:55], v[48:63]
  ds_read_b128 a[20:23], v17 offset:9216
  ds_read_b64_tr_b16 a[36:37], v24 offset:2048
  ds_read_b64_tr_b16 a[38:39], v24 offset:3072
  s_waitcnt lgkmcnt(8)
  v_mfma_f32_32x32x16_bf16 v[48:63], a[8:11], a[56:59], v[48:63]
  ds_read_b128 a[24:27], v17 offset:10240
  ds_read_b64_tr_b16 a[40:41], v24 offset:4096
  ds_read_b64_tr_b16 a[42:43], v24 offset:5120
  s_waitcnt lgkmcnt(9)
  v_mfma_f32_32x32x16_bf16 v[48:63], a[12:15], a[60:63], v[48:63]
  ds_read_b128 a[28:31], v17 offset:11264
  ds_read_b64_tr_b16 a[44:45], v24 offset:6144
  ds_read_b64_tr_b16 a[46:47], v24 offset:7168
  v_add_u32 v24, 73728, v19
  s_barrier
  s_waitcnt lgkmcnt(9)
  v_mfma_f32_32x32x16_bf16 v[64:79], a[16:19], a[32:35], 0
  ds_read_b128 a[0:3], v17 offset:16384
  ds_read_b64_tr_b16 a[48:49], v24 offset:0
  ds_read_b64_tr_b16 a[50:51], v24 offset:1024
  s_waitcnt lgkmcnt(9)
  v_mfma_f32_32x32x16_bf16 v[64:79], a[20:23], a[36:39], v[64:79]
  ds_read_b128 a[4:7], v17 offset:17408
  ds_read_b64_tr_b16 a[52:53], v24 offset:2048
  ds_read_b64_tr_b16 a[54:55], v24 offset:3072
  s_waitcnt lgkmcnt(9)
  v_mfma_f32_32x32x16_bf16 v[64:79], a[24:27], a[40:43], v[64:79]
  ds_read_b128 a[8:11], v17 offset:18432
  ds_read_b64_tr_b16 a[56:57], v24 offset:4096
  ds_read_b64_tr_b16 a[58:59], v24 offset:5120
  s_waitcnt lgkmcnt(9)
  v_mfma_f32_32x32x16_bf16 v[64:79], a[28:31], a[44:47], v[64:79]
  ds_read_b128 a[12:15], v17 offset:19456
  ds_read_b64_tr_b16 a[60:61], v24 offset:6144
  ds_read_b64_tr_b16 a[62:63], v24 offset:7168
  v_mul_f32 v32, v96, v32
  v_mul_f32 v33, v98, v33
  v_add_u32 v24, 81920, v19
  s_barrier
  s_waitcnt lgkmcnt(9)
  v_mfma_f32_32x32x16_bf16 v[64:79], a[0:3], a[48:51], v[64:79]
  ds_read_b128 a[16:19], v17 offset:24576
  ds_read_b64_tr_b16 a[64:65], v24 offset:0
  ds_read_b64_tr_b16 a[66:67], v24 offset:1024
  s_waitcnt lgkmcnt(9)
  v_mfma_f32_32x32x16_bf16 v[64:79], a[4:7], a[52:55], v[64:79]
  ds_read_b128 a[20:23], v17 offset:25600
  ds_read_b64_tr_b16 a[68:69], v24 offset:2048
  ds_read_b64_tr_b16 a[70:71], v24 offset:3072
  s_waitcnt lgkmcnt(9)
  v_mfma_f32_32x32x16_bf16 v[64:79], a[8:11], a[56:59], v[64:79]
  ds_read_b128 a[24:27], v17 offset:26624
  ds_read_b64_tr_b16 a[72:73], v24 offset:4096
  ds_read_b64_tr_b16 a[74:75], v24 offset:5120
  s_waitcnt lgkmcnt(9)
  v_mfma_f32_32x32x16_bf16 v[64:79], a[12:15], a[60:63], v[64:79]
  ds_read_b128 a[28:31], v17 offset:27648
  ds_read_b64_tr_b16 a[76:77], v24 offset:6144
  ds_read_b64_tr_b16 a[78:79], v24 offset:7168
  v_mul_f32 v34, v100, v34
  v_mul_f32 v35, v102, v35
  v_add_u32 v24, 90112, v19
  s_barrier
  s_waitcnt lgkmcnt(9)
  v_mfma_f32_32x32x16_bf16 v[64:79], a[16:19], a[64:67], v[64:79]
  ds_read_b128 a[0:3], v17 offset:32768
  ds_read_b64_tr_b16 a[32:33], v24 offset:0
  ds_read_b64_tr_b16 a[34:35], v24 offset:1024
  s_waitcnt lgkmcnt(9)
  v_mfma_f32_32x32x16_bf16 v[64:79], a[20:23], a[68:71], v[64:79]
  ds_read_b128 a[4:7], v17 offset:33792
  ds_read_b64_tr_b16 a[36:37], v24 offset:2048
  ds_read_b64_tr_b16 a[38:39], v24 offset:3072
  s_waitcnt lgkmcnt(9)
  v_mfma_f32_32x32x16_bf16 v[64:79], a[24:27], a[72:75], v[64:79]
  ds_read_b128 a[8:11], v17 offset:34816
  ds_read_b64_tr_b16 a[40:41], v24 offset:4096
  ds_read_b64_tr_b16 a[42:43], v24 offset:5120
  s_waitcnt lgkmcnt(9)
  v_mfma_f32_32x32x16_bf16 v[64:79], a[28:31], a[76:79], v[64:79]
  ds_read_b128 a[12:15], v17 offset:35840
  ds_read_b64_tr_b16 a[44:45], v24 offset:6144
  ds_read_b64_tr_b16 a[46:47], v24 offset:7168
  v_mul_f32 v36, v104, v36
  v_mul_f32 v37, v106, v37
  v_add_u32 v24, 0, v19
  s_barrier
  s_waitcnt lgkmcnt(9)
  v_mfma_f32_32x32x16_bf16 v[64:79], a[0:3], a[32:35], v[64:79]
  ds_read_b128 a[16:19], v17 offset:40960
  ds_read_b64_tr_b16 a[48:49], v24 offset:0
  ds_read_b64_tr_b16 a[50:51], v24 offset:1024
  s_waitcnt lgkmcnt(9)
  v_mfma_f32_32x32x16_bf16 v[64:79], a[4:7], a[36:39], v[64:79]
  ds_read_b128 a[20:23], v17 offset:41984
  ds_read_b64_tr_b16 a[52:53], v24 offset:2048
  ds_read_b64_tr_b16 a[54:55], v24 offset:3072
  s_waitcnt lgkmcnt(9)
  v_mfma_f32_32x32x16_bf16 v[64:79], a[8:11], a[40:43], v[64:79]
  ds_read_b128 a[24:27], v17 offset:43008
  ds_read_b64_tr_b16 a[56:57], v24 offset:4096
  ds_read_b64_tr_b16 a[58:59], v24 offset:5120
  s_waitcnt lgkmcnt(9)
  v_mfma_f32_32x32x16_bf16 v[64:79], a[12:15], a[44:47], v[64:79]
  ds_read_b128 a[28:31], v17 offset:44032
  ds_read_b64_tr_b16 a[60:61], v24 offset:6144
  ds_read_b64_tr_b16 a[62:63], v24 offset:7168
  v_mul_f32 v38, v108, v38
  v_mul_f32 v39, v110, v39
  v_add_u32 v24, 8192, v19
  s_barrier
  s_waitcnt lgkmcnt(9)
  v_mfma_f32_32x32x16_bf16 v[64:79], a[16:19], a[48:51], v[64:79]
  ds_read_b128 a[0:3], v17 offset:49152
  ds_read_b64_tr_b16 a[64:65], v24 offset:0
  ds_read_b64_tr_b16 a[66:67], v24 offset:1024
  s_waitcnt lgkmcnt(9)
  v_mfma_f32_32x32x16_bf16 v[64:79], a[20:23], a[52:55], v[64:79]
  ds_read_b128 a[4:7], v17 offset:50176
  ds_read_b64_tr_b16 a[68:69], v24 offset:2048
  ds_read_b64_tr_b16 a[70:71], v24 offset:3072
  s_waitcnt lgkmcnt(9)
  v_mfma_f32_32x32x16_bf16 v[64:79], a[24:27], a[56:59], v[64:79]
  ds_read_b128 a[8:11], v17 offset:51200
  ds_read_b64_tr_b16 a[72:73], v24 offset:4096
  ds_read_b64_tr_b16 a[74:75], v24 offset:5120
  s_waitcnt lgkmcnt(9)
  v_mfma_f32_32x32x16_bf16 v[64:79], a[28:31], a[60:63], v[64:79]
  ds_read_b128 a[12:15], v17 offset:52224
  ds_read_b64_tr_b16 a[76:77], v24 offset:6144
  ds_read_b64_tr_b16 a[78:79], v24 offset:7168
  v_mul_f32 v40, v112, v40
  v_mul_f32 v41, v114, v41
  v_add_u32 v24, 16384, v19
  s_barrier
  s_waitcnt lgkmcnt(9)
  v_mfma_f32_32x32x16_bf16 v[64:79], a[0:3], a[64:67], v[64:79]
  ds_read_b128 a[16:19], v17 offset:0
  ds_read_b64_tr_b16 a[32:33], v24 offset:0
  ds_read_b64_tr_b16 a[34:35], v24 offset:1024
  s_waitcnt lgkmcnt(9)
  v_mfma_f32_32x32x16_bf16 v[64:79], a[4:7], a[68:71], v[64:79]
  ds_read_b128 a[20:23], v17 offset:1024
  ds_read_b64_tr_b16 a[36:37], v24 offset:2048
  ds_read_b64_tr_b16 a[38:39], v24 offset:3072
  s_waitcnt lgkmcnt(9)
  v_mfma_f32_32x32x16_bf16 v[64:79], a[8:11], a[72:75], v[64:79]
  ds_read_b128 a[24:27], v17 offset:2048
  ds_read_b64_tr_b16 a[40:41], v24 offset:4096
  ds_read_b64_tr_b16 a[42:43], v24 offset:5120
  s_waitcnt lgkmcnt(9)
  v_mfma_f32_32x32x16_bf16 v[64:79], a[12:15], a[76:79], v[64:79]
  ds_read_b128 a[28:31], v17 offset:3072
  ds_read_b64_tr_b16 a[44:45], v24 offset:6144
  ds_read_b64_tr_b16 a[46:47], v24 offset:7168
  v_mul_f32 v42, v116, v42
  v_mul_f32 v43, v118, v43
  v_add_u32 v24, 24576, v19
  s_barrier
  s_waitcnt lgkmcnt(9)
  v_mfma_f32_32x32x16_bf16 v[64:79], a[16:19], a[32:35], v[64:79]
  ds_read_b128 a[0:3], v17 offset:8192
  ds_read_b64_tr_b16 a[48:49], v24 offset:0
  ds_read_b64_tr_b16 a[50:51], v24 offset:1024
  s_waitcnt lgkmcnt(9)
  v_mfma_f32_32x32x16_bf16 v[64:79], a[20:23], a[36:39], v[64:79]
  ds_read_b128 a[4:7], v17 offset:9216
  ds_read_b64_tr_b16 a[52:53], v24 offset:2048
  ds_read_b64_tr_b16 a[54:55], v24 offset:3072
  s_waitcnt lgkmcnt(9)
  v_mfma_f32_32x32x16_bf16 v[64:79], a[24:27], a[40:43], v[64:79]
  ds_read_b128 a[8:11], v17 offset:10240
  ds_read_b64_tr_b16 a[56:57], v24 offset:4096
  ds_read_b64_tr_b16 a[58:59], v24 offset:5120
  s_waitcnt lgkmcnt(9)
  v_mfma_f32_32x32x16_bf16 v[64:79], a[28:31], a[44:47], v[64:79]
  ds_read_b128 a[12:15], v17 offset:11264
  ds_read_b64_tr_b16 a[60:61], v24 offset:6144
  ds_read_b64_tr_b16 a[62:63], v24 offset:7168
  v_mul_f32 v44, v120, v44
  v_mul_f32 v45, v122, v45
  v_add_u32 v24, 32768, v19
  s_barrier
  s_waitcnt lgkmcnt(9)
  v_mfma_f32_32x32x16_bf16 v[64:79], a[0:3], a[48:51], v[64:79]
  ds_read_b128 a[16:19], v17 offset:16384
  ds_read_b64_tr_b16 a[64:65], v24 offset:0
  ds_read_b64_tr_b16 a[66:67], v24 offset:1024
  s_waitcnt lgkmcnt(9)
  v_mfma_f32_32x32x16_bf16 v[64:79], a[4:7], a[52:55], v[64:79]
  ds_read_b128 a[20:23], v17 offset:17408
  ds_read_b64_tr_b16 a[68:69], v24 offset:2048
  ds_read_b64_tr_b16 a[70:71], v24 offset:3072
  s_waitcnt lgkmcnt(9)
  v_mfma_f32_32x32x16_bf16 v[64:79], a[8:11], a[56:59], v[64:79]
  ds_read_b128 a[24:27], v17 offset:18432
  ds_read_b64_tr_b16 a[72:73], v24 offset:4096
  ds_read_b64_tr_b16 a[74:75], v24 offset:5120
  s_waitcnt lgkmcnt(9)
  v_mfma_f32_32x32x16_bf16 v[64:79], a[12:15], a[60:63], v[64:79]
  ds_read_b128 a[28:31], v17 offset:19456
  ds_read_b64_tr_b16 a[76:77], v24 offset:6144
  ds_read_b64_tr_b16 a[78:79], v24 offset:7168
  v_mul_f32 v46, v124, v46
  v_mul_f32 v47, v126, v47
  v_add_u32 v24, 40960, v19
  s_barrier
  s_waitcnt lgkmcnt(9)
  v_mfma_f32_32x32x16_bf16 v[64:79], a[16:19], a[64:67], v[64:79]
  ds_read_b128 a[0:3], v17 offset:24576
  ds_read_b64_tr_b16 a[32:33], v24 offset:0
  ds_read_b64_tr_b16 a[34:35], v24 offset:1024
  s_waitcnt lgkmcnt(9)
  v_mfma_f32_32x32x16_bf16 v[64:79], a[20:23], a[68:71], v[64:79]
  ds_read_b128 a[4:7], v17 offset:25600
  ds_read_b64_tr_b16 a[36:37], v24 offset:2048
  ds_read_b64_tr_b16 a[38:39], v24 offset:3072
  s_waitcnt lgkmcnt(9)
  v_mfma_f32_32x32x16_bf16 v[64:79], a[24:27], a[72:75], v[64:79]
  ds_read_b128 a[8:11], v17 offset:26624
  ds_read_b64_tr_b16 a[40:41], v24 offset:4096
  ds_read_b64_tr_b16 a[42:43], v24 offset:5120
  s_waitcnt lgkmcnt(9)
  v_mfma_f32_32x32x16_bf16 v[64:79], a[28:31], a[76:79], v[64:79]
  ds_read_b128 a[12:15], v17 offset:27648
  ds_read_b64_tr_b16 a[44:45], v24 offset:6144
  ds_read_b64_tr_b16 a[46:47], v24 offset:7168
  v_add_u32 v24, 49152, v19
  s_barrier
  s_waitcnt lgkmcnt(9)
  v_mfma_f32_32x32x16_bf16 v[64:79], a[0:3], a[32:35], v[64:79]
  ds_read_b128 a[16:19], v17 offset:32768
  ds_read_b64_tr_b16 a[48:49], v24 offset:0
  ds_read_b64_tr_b16 a[50:51], v24 offset:1024
  s_waitcnt lgkmcnt(9)
  v_mfma_f32_32x32x16_bf16 v[64:79], a[4:7], a[36:39], v[64:79]
  ds_read_b128 a[20:23], v17 offset:33792
  ds_read_b64_tr_b16 a[52:53], v24 offset:2048
  ds_read_b64_tr_b16 a[54:55], v24 offset:3072
  s_waitcnt lgkmcnt(9)
  v_mfma_f32_32x32x16_bf16 v[64:79], a[8:11], a[40:43], v[64:79]
  ds_read_b128 a[24:27], v17 offset:34816
  ds_read_b64_tr_b16 a[56:57], v24 offset:4096
  ds_read_b64_tr_b16 a[58:59], v24 offset:5120
  s_waitcnt lgkmcnt(9)
  v_mfma_f32_32x32x16_bf16 v[64:79], a[12:15], a[44:47], v[64:79]
  ds_read_b128 a[28:31], v17 offset:35840
  ds_read_b64_tr_b16 a[60:61], v24 offset:6144
  ds_read_b64_tr_b16 a[62:63], v24 offset:7168
  s_barrier
  s_waitcnt lgkmcnt(9)
  v_mfma_f32_32x32x16_bf16 v[64:79], a[16:19], a[48:51], v[64:79]
  ds_read_b64_tr_b16 a[0:1], v11 offset:40960
  ds_read_b64_tr_b16 a[2:3], v10 offset:40960
  s_waitcnt lgkmcnt(8)
  v_mfma_f32_32x32x16_bf16 v[64:79], a[20:23], a[52:55], v[64:79]
  ds_read_b64_tr_b16 a[4:5], v11 offset:41472
  ds_read_b64_tr_b16 a[6:7], v10 offset:41472
  s_waitcnt lgkmcnt(7)
  v_mfma_f32_32x32x16_bf16 v[64:79], a[24:27], a[56:59], v[64:79]
  ds_read_b64_tr_b16 a[8:9], v11 offset:43008
  ds_read_b64_tr_b16 a[10:11], v10 offset:43008
  s_waitcnt lgkmcnt(6)
  v_mfma_f32_32x32x16_bf16 v[64:79], a[28:31], a[60:63], v[64:79]
  ds_read_b64_tr_b16 a[12:13], v11 offset:43520
  ds_read_b64_tr_b16 a[14:15], v10 offset:43520
  s_nop 10
  v_fmac_f32 v32, v97, v64
  v_fmac_f32 v33, v99, v65
  v_fmac_f32 v34, v101, v66
  v_fmac_f32 v35, v103, v67
  v_cvt_pk_bf16_f32 v80, v32, v33
  v_cvt_pk_bf16_f32 v82, v34, v35
  buffer_store_dwordx4 v[80:83], v6, s[88:91], s101 offen offset:0 sc1
  v_fmac_f32 v36, v105, v68
  v_fmac_f32 v37, v107, v69
  v_fmac_f32 v38, v109, v70
  v_fmac_f32 v39, v111, v71
  v_cvt_pk_bf16_f32 v84, v36, v37
  v_cvt_pk_bf16_f32 v86, v38, v39
  buffer_store_dwordx4 v[84:87], v6, s[88:91], s101 offen offset:1024 sc1
  s_barrier
  s_waitcnt lgkmcnt(6)
  v_mfma_f32_32x32x16_bf16 v[48:63], a[0:3], a[80:83], v[48:63]
  ds_read_b64_tr_b16 a[16:17], v11 offset:49152
  ds_read_b64_tr_b16 a[18:19], v10 offset:49152
  s_waitcnt lgkmcnt(6)
  v_mfma_f32_32x32x16_bf16 v[48:63], a[4:7], a[84:87], v[48:63]
  ds_read_b64_tr_b16 a[20:21], v11 offset:49664
  ds_read_b64_tr_b16 a[22:23], v10 offset:49664
  s_waitcnt lgkmcnt(6)
  v_mfma_f32_32x32x16_bf16 v[48:63], a[8:11], a[88:91], v[48:63]
  ds_read_b64_tr_b16 a[24:25], v11 offset:51200
  ds_read_b64_tr_b16 a[26:27], v10 offset:51200
  s_waitcnt lgkmcnt(6)
  v_mfma_f32_32x32x16_bf16 v[48:63], a[12:15], a[92:95], v[48:63]
  ds_read_b64_tr_b16 a[28:29], v11 offset:51712
  ds_read_b64_tr_b16 a[30:31], v10 offset:51712
  v_fmac_f32 v40, v113, v72
  v_fmac_f32 v41, v115, v73
  v_fmac_f32 v42, v117, v74
  v_fmac_f32 v43, v119, v75
  v_cvt_pk_bf16_f32 v88, v40, v41
  v_cvt_pk_bf16_f32 v90, v42, v43
  buffer_store_dwordx4 v[88:91], v6, s[88:91], s101 offen offset:2048 sc1
  v_fmac_f32 v44, v121, v76
  v_fmac_f32 v45, v123, v77
  v_fmac_f32 v46, v125, v78
  v_fmac_f32 v47, v127, v79
  v_cvt_pk_bf16_f32 v92, v44, v45
  v_cvt_pk_bf16_f32 v94, v46, v47
  buffer_store_dwordx4 v[92:95], v6, s[88:91], s101 offen offset:3072 sc1
  v_add_u32 v24, 65536, v19
  s_barrier
  s_waitcnt lgkmcnt(6)
  v_mfma_f32_32x32x16_bf16 v[48:63], a[16:19], a[96:99], v[48:63]
  ds_read_b128 a[0:3], v17 offset:0
  ds_read_b64_tr_b16 a[48:49], v24 offset:0
  ds_read_b64_tr_b16 a[50:51], v24 offset:1024
  s_waitcnt lgkmcnt(7)
  v_mfma_f32_32x32x16_bf16 v[48:63], a[20:23], a[100:103], v[48:63]
  ds_read_b128 a[4:7], v17 offset:1024
  ds_read_b64_tr_b16 a[52:53], v24 offset:2048
  ds_read_b64_tr_b16 a[54:55], v24 offset:3072
  s_waitcnt lgkmcnt(8)
  v_mfma_f32_32x32x16_bf16 v[48:63], a[24:27], a[104:107], v[48:63]
  ds_read_b128 a[8:11], v17 offset:2048
  ds_read_b64_tr_b16 a[56:57], v24 offset:4096
  ds_read_b64_tr_b16 a[58:59], v24 offset:5120
  s_waitcnt lgkmcnt(9)
  v_mfma_f32_32x32x16_bf16 v[48:63], a[28:31], a[108:111], v[48:63]
  ds_read_b128 a[12:15], v17 offset:3072
  ds_read_b64_tr_b16 a[60:61], v24 offset:6144
  ds_read_b64_tr_b16 a[62:63], v24 offset:7168
  ds_read_b128 v[96:99], v22 offset:0
  ds_read_b128 v[100:103], v22 offset:16
  ds_read_b128 v[104:107], v22 offset:32
  ds_read_b128 v[108:111], v22 offset:48
  ds_read_b128 v[112:115], v22 offset:64
  ds_read_b128 v[116:119], v22 offset:80
  ds_read_b128 v[120:123], v22 offset:96
  ds_read_b128 v[124:127], v22 offset:112
  v_add_u32 v24, 73728, v19
  s_barrier
  s_waitcnt lgkmcnt(15)
  v_mfma_f32_32x32x16_bf16 v[80:95], a[0:3], a[48:51], 0
  ds_read_b128 a[16:19], v17 offset:8192
  ds_read_b64_tr_b16 a[64:65], v24 offset:0
  ds_read_b64_tr_b16 a[66:67], v24 offset:1024
  s_waitcnt lgkmcnt(15)
  v_mfma_f32_32x32x16_bf16 v[80:95], a[4:7], a[52:55], v[80:95]
  ds_read_b128 a[20:23], v17 offset:9216
  ds_read_b64_tr_b16 a[68:69], v24 offset:2048
  ds_read_b64_tr_b16 a[70:71], v24 offset:3072
  s_waitcnt lgkmcnt(15)
  v_mfma_f32_32x32x16_bf16 v[80:95], a[8:11], a[56:59], v[80:95]
  ds_read_b128 a[24:27], v17 offset:10240
  ds_read_b64_tr_b16 a[72:73], v24 offset:4096
  ds_read_b64_tr_b16 a[74:75], v24 offset:5120
  s_waitcnt lgkmcnt(15)
  v_mfma_f32_32x32x16_bf16 v[80:95], a[12:15], a[60:63], v[80:95]
  ds_read_b128 a[28:31], v17 offset:11264
  ds_read_b64_tr_b16 a[76:77], v24 offset:6144
  ds_read_b64_tr_b16 a[78:79], v24 offset:7168
  v_add_u32 v24, 81920, v19
  s_barrier
  s_waitcnt lgkmcnt(9)
  v_mfma_f32_32x32x16_bf16 v[80:95], a[16:19], a[64:67], v[80:95]
  ds_read_b128 a[0:3], v17 offset:16384
  ds_read_b64_tr_b16 a[32:33], v24 offset:0
  ds_read_b64_tr_b16 a[34:35], v24 offset:1024
  s_waitcnt lgkmcnt(9)
  v_mfma_f32_32x32x16_bf16 v[80:95], a[20:23], a[68:71], v[80:95]
  ds_read_b128 a[4:7], v17 offset:17408
  ds_read_b64_tr_b16 a[36:37], v24 offset:2048
  ds_read_b64_tr_b16 a[38:39], v24 offset:3072
  s_waitcnt lgkmcnt(9)
  v_mfma_f32_32x32x16_bf16 v[80:95], a[24:27], a[72:75], v[80:95]
  ds_read_b128 a[8:11], v17 offset:18432
  ds_read_b64_tr_b16 a[40:41], v24 offset:4096
  ds_read_b64_tr_b16 a[42:43], v24 offset:5120
  s_waitcnt lgkmcnt(9)
  v_mfma_f32_32x32x16_bf16 v[80:95], a[28:31], a[76:79], v[80:95]
  ds_read_b128 a[12:15], v17 offset:19456
  ds_read_b64_tr_b16 a[44:45], v24 offset:6144
  ds_read_b64_tr_b16 a[46:47], v24 offset:7168
  v_add_u32 v24, 90112, v19
  s_barrier
  s_waitcnt lgkmcnt(9)
  v_mfma_f32_32x32x16_bf16 v[80:95], a[0:3], a[32:35], v[80:95]
  ds_read_b128 a[16:19], v17 offset:24576
  ds_read_b64_tr_b16 a[48:49], v24 offset:0
  ds_read_b64_tr_b16 a[50:51], v24 offset:1024
  s_waitcnt lgkmcnt(9)
  v_mfma_f32_32x32x16_bf16 v[80:95], a[4:7], a[36:39], v[80:95]
  ds_read_b128 a[20:23], v17 offset:25600
  ds_read_b64_tr_b16 a[52:53], v24 offset:2048
  ds_read_b64_tr_b16 a[54:55], v24 offset:3072
  s_waitcnt lgkmcnt(9)
  v_mfma_f32_32x32x16_bf16 v[80:95], a[8:11], a[40:43], v[80:95]
  ds_read_b128 a[24:27], v17 offset:26624
  ds_read_b64_tr_b16 a[56:57], v24 offset:4096
  ds_read_b64_tr_b16 a[58:59], v24 offset:5120
  s_waitcnt lgkmcnt(9)
  v_mfma_f32_32x32x16_bf16 v[80:95], a[12:15], a[44:47], v[80:95]
  ds_read_b128 a[28:31], v17 offset:27648
  ds_read_b64_tr_b16 a[60:61], v24 offset:6144
  ds_read_b64_tr_b16 a[62:63], v24 offset:7168
  v_mul_f32 v48, v96, v48
  v_mul_f32 v49, v98, v49
  v_mul_f32 v50, v100, v50
  v_mul_f32 v51, v102, v51
  v_add_u32 v24, 0, v19
  s_barrier
  s_waitcnt lgkmcnt(9)
  v_mfma_f32_32x32x16_bf16 v[80:95], a[16:19], a[48:51], v[80:95]
  ds_read_b128 a[0:3], v17 offset:32768
  ds_read_b64_tr_b16 a[64:65], v24 offset:0
  ds_read_b64_tr_b16 a[66:67], v24 offset:1024
  s_waitcnt lgkmcnt(9)
  v_mfma_f32_32x32x16_bf16 v[80:95], a[20:23], a[52:55], v[80:95]
  ds_read_b128 a[4:7], v17 offset:33792
  ds_read_b64_tr_b16 a[68:69], v24 offset:2048
  ds_read_b64_tr_b16 a[70:71], v24 offset:3072
  s_waitcnt lgkmcnt(9)
  v_mfma_f32_32x32x16_bf16 v[80:95], a[24:27], a[56:59], v[80:95]
  ds_read_b128 a[8:11], v17 offset:34816
  ds_read_b64_tr_b16 a[72:73], v24 offset:4096
  ds_read_b64_tr_b16 a[74:75], v24 offset:5120
  s_waitcnt lgkmcnt(9)
  v_mfma_f32_32x32x16_bf16 v[80:95], a[28:31], a[60:63], v[80:95]
  ds_read_b128 a[12:15], v17 offset:35840
  ds_read_b64_tr_b16 a[76:77], v24 offset:6144
  ds_read_b64_tr_b16 a[78:79], v24 offset:7168
  v_mul_f32 v52, v104, v52
  v_mul_f32 v53, v106, v53
  v_mul_f32 v54, v108, v54
  v_mul_f32 v55, v110, v55
  v_add_u32 v24, 8192, v19
  s_barrier
  s_waitcnt lgkmcnt(9)
  v_mfma_f32_32x32x16_bf16 v[80:95], a[0:3], a[64:67], v[80:95]
  ds_read_b128 a[16:19], v17 offset:40960
  ds_read_b64_tr_b16 a[32:33], v24 offset:0
  ds_read_b64_tr_b16 a[34:35], v24 offset:1024
  s_waitcnt lgkmcnt(9)
  v_mfma_f32_32x32x16_bf16 v[80:95], a[4:7], a[68:71], v[80:95]
  ds_read_b128 a[20:23], v17 offset:41984
  ds_read_b64_tr_b16 a[36:37], v24 offset:2048
  ds_read_b64_tr_b16 a[38:39], v24 offset:3072
  s_waitcnt lgkmcnt(9)
  v_mfma_f32_32x32x16_bf16 v[80:95], a[8:11], a[72:75], v[80:95]
  ds_read_b128 a[24:27], v17 offset:43008
  ds_read_b64_tr_b16 a[40:41], v24 offset:4096
  ds_read_b64_tr_b16 a[42:43], v24 offset:5120
  s_waitcnt lgkmcnt(9)
  v_mfma_f32_32x32x16_bf16 v[80:95], a[12:15], a[76:79], v[80:95]
  ds_read_b128 a[28:31], v17 offset:44032
  ds_read_b64_tr_b16 a[44:45], v24 offset:6144
  ds_read_b64_tr_b16 a[46:47], v24 offset:7168
  v_mul_f32 v56, v112, v56
  v_mul_f32 v57, v114, v57
  v_mul_f32 v58, v116, v58
  v_mul_f32 v59, v118, v59
  v_add_u32 v24, 16384, v19
  s_barrier
  s_waitcnt lgkmcnt(9)
  v_mfma_f32_32x32x16_bf16 v[80:95], a[16:19], a[32:35], v[80:95]
  ds_read_b128 a[0:3], v17 offset:49152
  ds_read_b64_tr_b16 a[48:49], v24 offset:0
  ds_read_b64_tr_b16 a[50:51], v24 offset:1024
  s_waitcnt lgkmcnt(9)
  v_mfma_f32_32x32x16_bf16 v[80:95], a[20:23], a[36:39], v[80:95]
  ds_read_b128 a[4:7], v17 offset:50176
  ds_read_b64_tr_b16 a[52:53], v24 offset:2048
  ds_read_b64_tr_b16 a[54:55], v24 offset:3072
  s_waitcnt lgkmcnt(9)
  v_mfma_f32_32x32x16_bf16 v[80:95], a[24:27], a[40:43], v[80:95]
  ds_read_b128 a[8:11], v17 offset:51200
  ds_read_b64_tr_b16 a[56:57], v24 offset:4096
  ds_read_b64_tr_b16 a[58:59], v24 offset:5120
  s_waitcnt lgkmcnt(9)
  v_mfma_f32_32x32x16_bf16 v[80:95], a[28:31], a[44:47], v[80:95]
  ds_read_b128 a[12:15], v17 offset:52224
  ds_read_b64_tr_b16 a[60:61], v24 offset:6144
  ds_read_b64_tr_b16 a[62:63], v24 offset:7168
  v_mul_f32 v60, v120, v60
  v_mul_f32 v61, v122, v61
  v_mul_f32 v62, v124, v62
  v_mul_f32 v63, v126, v63
  v_add_u32 v24, 24576, v19
  s_barrier
  s_waitcnt lgkmcnt(9)
  v_mfma_f32_32x32x16_bf16 v[80:95], a[0:3], a[48:51], v[80:95]
  ds_read_b128 a[16:19], v17 offset:0
  ds_read_b64_tr_b16 a[64:65], v24 offset:0
  ds_read_b64_tr_b16 a[66:67], v24 offset:1024
  s_waitcnt lgkmcnt(9)
  v_mfma_f32_32x32x16_bf16 v[80:95], a[4:7], a[52:55], v[80:95]
  ds_read_b128 a[20:23], v17 offset:1024
  ds_read_b64_tr_b16 a[68:69], v24 offset:2048
  ds_read_b64_tr_b16 a[70:71], v24 offset:3072
  s_waitcnt lgkmcnt(9)
  v_mfma_f32_32x32x16_bf16 v[80:95], a[8:11], a[56:59], v[80:95]
  ds_read_b128 a[24:27], v17 offset:2048
  ds_read_b64_tr_b16 a[72:73], v24 offset:4096
  ds_read_b64_tr_b16 a[74:75], v24 offset:5120
  s_waitcnt lgkmcnt(9)
  v_mfma_f32_32x32x16_bf16 v[80:95], a[12:15], a[60:63], v[80:95]
  ds_read_b128 a[28:31], v17 offset:3072
  ds_read_b64_tr_b16 a[76:77], v24 offset:6144
  ds_read_b64_tr_b16 a[78:79], v24 offset:7168
  buffer_load_dwordx4 v[32:35], v6, s[88:91], s100 offen offset:0 sc1
  buffer_load_dwordx4 v[36:39], v6, s[88:91], s100 offen offset:1024 sc1
  buffer_load_dwordx4 v[40:43], v6, s[88:91], s100 offen offset:2048 sc1
  buffer_load_dwordx4 v[44:47], v6, s[88:91], s100 offen offset:3072 sc1
  v_add_u32 v24, 32768, v19
  s_barrier
  s_waitcnt lgkmcnt(9)
  v_mfma_f32_32x32x16_bf16 v[80:95], a[16:19], a[64:67], v[80:95]
  ds_read_b128 a[0:3], v17 offset:8192
  ds_read_b64_tr_b16 a[32:33], v24 offset:0
  ds_read_b64_tr_b16 a[34:35], v24 offset:1024
  s_waitcnt lgkmcnt(9)
  v_mfma_f32_32x32x16_bf16 v[80:95], a[20:23], a[68:71], v[80:95]
  ds_read_b128 a[4:7], v17 offset:9216
  ds_read_b64_tr_b16 a[36:37], v24 offset:2048
  ds_read_b64_tr_b16 a[38:39], v24 offset:3072
  s_waitcnt lgkmcnt(9)
  v_mfma_f32_32x32x16_bf16 v[80:95], a[24:27], a[72:75], v[80:95]
  ds_read_b128 a[8:11], v17 offset:10240
  ds_read_b64_tr_b16 a[40:41], v24 offset:4096
  ds_read_b64_tr_b16 a[42:43], v24 offset:5120
  s_waitcnt lgkmcnt(9)
  v_mfma_f32_32x32x16_bf16 v[80:95], a[28:31], a[76:79], v[80:95]
  ds_read_b128 a[12:15], v17 offset:11264
  ds_read_b64_tr_b16 a[44:45], v24 offset:6144
  ds_read_b64_tr_b16 a[46:47], v24 offset:7168
  v_add_u32 v24, 40960, v19
  s_barrier
  s_waitcnt lgkmcnt(9)
  v_mfma_f32_32x32x16_bf16 v[80:95], a[0:3], a[32:35], v[80:95]
  ds_read_b128 a[16:19], v17 offset:16384
  ds_read_b64_tr_b16 a[48:49], v24 offset:0
  ds_read_b64_tr_b16 a[50:51], v24 offset:1024
  s_waitcnt lgkmcnt(9)
  v_mfma_f32_32x32x16_bf16 v[80:95], a[4:7], a[36:39], v[80:95]
  ds_read_b128 a[20:23], v17 offset:17408
  ds_read_b64_tr_b16 a[52:53], v24 offset:2048
  ds_read_b64_tr_b16 a[54:55], v24 offset:3072
  s_waitcnt lgkmcnt(9)
  v_mfma_f32_32x32x16_bf16 v[80:95], a[8:11], a[40:43], v[80:95]
  ds_read_b128 a[24:27], v17 offset:18432
  ds_read_b64_tr_b16 a[56:57], v24 offset:4096
  ds_read_b64_tr_b16 a[58:59], v24 offset:5120
  s_waitcnt lgkmcnt(9)
  v_mfma_f32_32x32x16_bf16 v[80:95], a[12:15], a[44:47], v[80:95]
  ds_read_b128 a[28:31], v17 offset:19456
  ds_read_b64_tr_b16 a[60:61], v24 offset:6144
  ds_read_b64_tr_b16 a[62:63], v24 offset:7168
  v_add_u32 v24, 49152, v19
  s_barrier
  s_waitcnt lgkmcnt(9)
  v_mfma_f32_32x32x16_bf16 v[80:95], a[16:19], a[48:51], v[80:95]
  ds_read_b128 a[0:3], v17 offset:24576
  ds_read_b64_tr_b16 a[64:65], v24 offset:0
  ds_read_b64_tr_b16 a[66:67], v24 offset:1024
  s_waitcnt lgkmcnt(9)
  v_mfma_f32_32x32x16_bf16 v[80:95], a[20:23], a[52:55], v[80:95]
  ds_read_b128 a[4:7], v17 offset:25600
  ds_read_b64_tr_b16 a[68:69], v24 offset:2048
  ds_read_b64_tr_b16 a[70:71], v24 offset:3072
  s_waitcnt lgkmcnt(9)
  v_mfma_f32_32x32x16_bf16 v[80:95], a[24:27], a[56:59], v[80:95]
  ds_read_b128 a[8:11], v17 offset:26624
  ds_read_b64_tr_b16 a[72:73], v24 offset:4096
  ds_read_b64_tr_b16 a[74:75], v24 offset:5120
  s_waitcnt lgkmcnt(9)
  v_mfma_f32_32x32x16_bf16 v[80:95], a[28:31], a[60:63], v[80:95]
  ds_read_b128 a[12:15], v17 offset:27648
  ds_read_b64_tr_b16 a[76:77], v24 offset:6144
  ds_read_b64_tr_b16 a[78:79], v24 offset:7168
  s_mov_b32 s13, 0
L_F_rpoll:
  s_waitcnt vmcnt(0)
  v_min3_u32 v28, v33, v35, s86
  v_min3_u32 v28, v37, v39, v28
  v_min3_u32 v28, v41, v43, v28
  v_min3_u32 v28, v45, v47, v28
  v_max3_u32 v29, v33, v35, s86
  v_max3_u32 v29, v37, v39, v29
  v_max3_u32 v29, v41, v43, v29
  v_max3_u32 v29, v45, v47, v29
  v_cmp_ne_u32 vcc, v28, v29
  s_cbranch_vccz L_F_rok
  s_sleep 2
  buffer_load_dwordx4 v[32:35], v6, s[88:91], s100 offen offset:0 sc1
  buffer_load_dwordx4 v[36:39], v6, s[88:91], s100 offen offset:1024 sc1
  buffer_load_dwordx4 v[40:43], v6, s[88:91], s100 offen offset:2048 sc1
  buffer_load_dwordx4 v[44:47], v6, s[88:91], s100 offen offset:3072 sc1
  s_add_u32 s13, s13, 1
  s_cmp_lt_u32 s13, 0x20000
  s_cbranch_scc1 L_F_rpoll
  s_waitcnt vmcnt(0)
L_F_rok:
  s_waitcnt lgkmcnt(9)
  v_mfma_f32_32x32x16_bf16 v[80:95], a[0:3], a[64:67], v[80:95]
  s_waitcnt lgkmcnt(6)
  v_mfma_f32_32x32x16_bf16 v[80:95], a[4:7], a[68:71], v[80:95]
  s_waitcnt lgkmcnt(3)
  v_mfma_f32_32x32x16_bf16 v[80:95], a[8:11], a[72:75], v[80:95]
  s_waitcnt lgkmcnt(0)
  v_mfma_f32_32x32x16_bf16 v[80:95], a[12:15], a[76:79], v[80:95]
  v_and_b32 v33, 0xffff0000, v32
  v_lshlrev_b32 v32, 16, v32
  v_add_f32 v49, v49, v33
  v_add_f32 v48, v48, v32
  v_and_b32 v35, 0xffff0000, v34
  v_lshlrev_b32 v34, 16, v34
  v_add_f32 v51, v51, v35
  v_add_f32 v50, v50, v34
  v_and_b32 v37, 0xffff0000, v36
  v_lshlrev_b32 v36, 16, v36
  v_add_f32 v53, v53, v37
  v_add_f32 v52, v52, v36
  v_fmac_f32 v48, v97, v80
  s_movk_i32 s6, 0
  buffer_store_dword v48, v20, s[68:71], s6 offen offset:0 sc0 sc1
  v_and_b32 v39, 0xffff0000, v38
  v_lshlrev_b32 v38, 16, v38
  v_add_f32 v55, v55, v39
  v_add_f32 v54, v54, v38
  v_fmac_f32 v49, v99, v81
  buffer_store_dword v49, v20, s[68:71], s6 offen offset:2048 sc0 sc1
  v_fmac_f32 v50, v101, v82
  s_movk_i32 s6, 4096
  buffer_store_dword v50, v20, s[68:71], s6 offen offset:0 sc0 sc1
  v_and_b32 v41, 0xffff0000, v40
  v_lshlrev_b32 v40, 16, v40
  v_add_f32 v57, v57, v41
  v_add_f32 v56, v56, v40
  v_fmac_f32 v51, v103, v83
  buffer_store_dword v51, v20, s[68:71], s6 offen offset:2048 sc0 sc1
  v_fmac_f32 v52, v105, v84
  s_movk_i32 s6, 8192
  buffer_store_dword v52, v20, s[68:71], s6 offen offset:0 sc0 sc1
  v_and_b32 v43, 0xffff0000, v42
  v_lshlrev_b32 v42, 16, v42
  v_add_f32 v59, v59, v43
  v_add_f32 v58, v58, v42
  v_fmac_f32 v53, v107, v85
  buffer_store_dword v53, v20, s[68:71], s6 offen offset:2048 sc0 sc1
  v_fmac_f32 v54, v109, v86
  s_movk_i32 s6, 12288
  buffer_store_dword v54, v20, s[68:71], s6 offen offset:0 sc0 sc1
  v_and_b32 v45, 0xffff0000, v44
  v_lshlrev_b32 v44, 16, v44
  v_add_f32 v61, v61, v45
  v_add_f32 v60, v60, v44
  v_fmac_f32 v55, v111, v87
  buffer_store_dword v55, v20, s[68:71], s6 offen offset:2048 sc0 sc1
  v_fmac_f32 v56, v113, v88
  s_movk_i32 s6, 16384
  buffer_store_dword v56, v20, s[68:71], s6 offen offset:0 sc0 sc1
  v_and_b32 v47, 0xffff0000, v46
  v_lshlrev_b32 v46, 16, v46
  v_add_f32 v63, v63, v47
  v_add_f32 v62, v62, v46
  v_fmac_f32 v57, v115, v89
  buffer_store_dword v57, v20, s[68:71], s6 offen offset:2048 sc0 sc1
  v_fmac_f32 v58, v117, v90
  s_movk_i32 s6, 20480
  buffer_store_dword v58, v20, s[68:71], s6 offen offset:0 sc0 sc1
  v_fmac_f32 v59, v119, v91
  buffer_store_dword v59, v20, s[68:71], s6 offen offset:2048 sc0 sc1
  v_fmac_f32 v60, v121, v92
  s_movk_i32 s6, 24576
  buffer_store_dword v60, v20, s[68:71], s6 offen offset:0 sc0 sc1
  v_fmac_f32 v61, v123, v93
  buffer_store_dword v61, v20, s[68:71], s6 offen offset:2048 sc0 sc1
  v_fmac_f32 v62, v125, v94
  s_movk_i32 s6, 28672
  buffer_store_dword v62, v20, s[68:71], s6 offen offset:0 sc0 sc1
  v_fmac_f32 v63, v127, v95
  buffer_store_dword v63, v20, s[68:71], s6 offen offset:2048 sc0 sc1
  s_endpgm
L_end:
  s_endpgm
L_code_end:
.section .rodata,"a"
.p2align 6
.amdhsa_kernel gated_mix__ssm_conv_s5__glu_gated_swiglu__prompt_kernel
  .amdhsa_next_free_vgpr 256
  .amdhsa_next_free_sgpr 102
  .amdhsa_accum_offset 128
  .amdhsa_group_segment_fixed_size 0
  .amdhsa_kernarg_size 136
  .amdhsa_user_sgpr_count 2
  .amdhsa_user_sgpr_kernarg_segment_ptr 1
  .amdhsa_system_sgpr_workgroup_id_x 1
.end_amdhsa_kernel
```
